```python
import torch

def _softmax(x, axis=-1):
    return torch.softmax(x, dim=axis)
def _gelu(x):
    return torch.nn.functional.gelu(x, approximate="tanh")
def _silu(x):
    return torch.nn.functional.silu(x)
def _sigmoid(x):
    return torch.sigmoid(x)
def _layernorm(x, axis=-1, eps=1e-5):
    m = x.mean(dim=axis, keepdim=True)
    v = x.var(dim=axis, keepdim=True, unbiased=False)
    return (x - m) / torch.sqrt(v + eps)
def _scatter_add(tgt, idx, src, axis=0):
    return tgt.clone().index_add_(axis, idx, src)
def _segment_sum(src, seg, n):
    out = torch.zeros((n,) + src.shape[1:], dtype=src.dtype)
    return out.index_add_(0, seg, src)
def _pad(x, pw):
    flat = tuple(v for pair in reversed(pw) for v in pair)
    return torch.nn.functional.pad(x, flat)

kernel_name = 'concat_heads__gqa_block_cached__gqa_block_cached__near_ridge'

def setup_inputs():

    _w = (lambda a: (lambda t: t.to(torch.bfloat16) if t.is_floating_point() else t)(torch.as_tensor(a)))
    def _A_setup():
        B, Sq, D = 8, 96, 576
        Hq, Hkv, Sk, Dh = 32, 16, 1024, 128
        assert Hq % Hkv == 0, (Hq, Hkv)
        return {
            "x": _w((lambda *s: torch.randn(*s, dtype=torch.bfloat16) * 0.8)(B, Sq, D)),
            "k_cache": _w((lambda *s: torch.randn(*s, dtype=torch.bfloat16) * 0.8)(B, Hkv, Sk, Dh)),
            "v_cache": _w((lambda *s: torch.randn(*s, dtype=torch.bfloat16) * 0.05)(B, Hkv, Sk, Dh)),
            "wq": _w((lambda *s: torch.randn(*s, dtype=torch.bfloat16) * 0.8)(D, Hq * Dh) * (D ** -0.5)),
            "wo": _w((lambda *s: torch.randn(*s, dtype=torch.bfloat16) * 0.05)(Hq * Dh, D) * ((Hq * Dh) ** -0.5)),
        }
    _A_in = _A_setup()

    def _B_setup():
        B, Sq, D = 8, 96, 576
        Hq, Hkv, Sk, Dh = 32, 16, 1024, 128
        assert Hq % Hkv == 0, (Hq, Hkv)
        return {
            "x": _w((lambda *s: torch.randn(*s, dtype=torch.bfloat16) * 0.8)(B, Sq, D)),
            "k_cache": _w((lambda *s: torch.randn(*s, dtype=torch.bfloat16) * 0.8)(B, Hkv, Sk, Dh)),
            "v_cache": _w((lambda *s: torch.randn(*s, dtype=torch.bfloat16) * 0.05)(B, Hkv, Sk, Dh)),
            "wq": _w((lambda *s: torch.randn(*s, dtype=torch.bfloat16) * 0.8)(D, Hq * Dh) * (D ** -0.5)),
            "wo": _w((lambda *s: torch.randn(*s, dtype=torch.bfloat16) * 0.05)(Hq * Dh, D) * ((Hq * Dh) ** -0.5)),
        }
    _B_in = _B_setup()

    return {
        "A_x": _A_in["x"],
        "A_k_cache": _A_in["k_cache"],
        "A_v_cache": _A_in["v_cache"],
        "A_wq": _A_in["wq"],
        "A_wo": _A_in["wo"],
        "B_x": _B_in["x"],
        "B_k_cache": _B_in["k_cache"],
        "B_v_cache": _B_in["v_cache"],
        "B_wq": _B_in["wq"],
        "B_wo": _B_in["wo"],
    }

def reference(A_x, A_k_cache, A_v_cache, A_wq, A_wo, B_x, B_k_cache, B_v_cache, B_wq, B_wo):
    def _A_ref(x, k_cache, v_cache, wq, wo):
        B, Sq, D = x.shape
        Hq, Dh = 32, 128
        Hkv = k_cache.shape[1]
        rep = Hq // Hkv
        q = (lambda x, *d: x.permute(*d))((x @ wq).reshape(B, Sq, Hq, Dh), 0, 2, 1, 3)
        k = (lambda x, n, axis: torch.repeat_interleave(x, n, dim=axis))(k_cache, rep, axis=1)
        v = (lambda x, n, axis: torch.repeat_interleave(x, n, dim=axis))(v_cache, rep, axis=1)
        scores = torch.einsum("bhqd,bhkd->bhqk", q, k) * (Dh ** -0.5)
        p = _softmax(scores, axis=-1)
        o = torch.einsum("bhqk,bhkd->bhqd", p, v)
        return (lambda x, *d: x.permute(*d))(o, 0, 2, 1, 3).reshape(B, Sq, Hq * Dh) @ wo

    def _B_ref(x, k_cache, v_cache, wq, wo):
        B, Sq, D = x.shape
        Hq, Dh = 32, 128
        Hkv = k_cache.shape[1]
        rep = Hq // Hkv
        q = (lambda x, *d: x.permute(*d))((x @ wq).reshape(B, Sq, Hq, Dh), 0, 2, 1, 3)
        k = (lambda x, n, axis: torch.repeat_interleave(x, n, dim=axis))(k_cache, rep, axis=1)
        v = (lambda x, n, axis: torch.repeat_interleave(x, n, dim=axis))(v_cache, rep, axis=1)
        scores = torch.einsum("bhqd,bhkd->bhqk", q, k) * (Dh ** -0.5)
        p = _softmax(scores, axis=-1)
        o = torch.einsum("bhqk,bhkd->bhqd", p, v)
        return (lambda x, *d: x.permute(*d))(o, 0, 2, 1, 3).reshape(B, Sq, Hq * Dh) @ wo

    a = _A_ref(A_x, A_k_cache, A_v_cache, A_wq, A_wo)
    b = _B_ref(B_x, B_k_cache, B_v_cache, B_wq, B_wo)
    return torch.concatenate([a, b], axis=-1)
```

```asm
; @launch grid=(256,1,1) block=(256,1,1) lds=163840
.amdgcn_target "amdgcn-amd-amdhsa--gfx950"
.text
.globl concat_heads__gqa_block_cached__gqa_block_cached__near_ridge_kernel
.p2align 8
.type concat_heads__gqa_block_cached__gqa_block_cached__near_ridge_kernel,@function
concat_heads__gqa_block_cached__gqa_block_cached__near_ridge_kernel:
    s_cmp_ge_u32 s2, 256
    s_cbranch_scc1 L1_end
    s_load_dwordx16 s[4:19], s[0:1], 0
    s_load_dwordx8 s[20:27], s[0:1], 64
    s_load_dwordx2 s[28:29], s[0:1], 96
    v_lshrrev_b32 v1, 6, v0
    v_and_b32 v0, 63, v0
    v_readfirstlane_b32 s52, v1
    s_and_b32 s3, s2, 7
    s_lshr_b32 s55, s3, 2
    s_and_b32 s3, s3, 3
    s_lshl_b32 s3, s3, 2
    s_lshr_b32 s61, s2, 3
    s_lshr_b32 s57, s61, 2
    s_and_b32 s61, s61, 3
    s_add_u32 s56, s3, s61
    s_and_b32 s53, s52, 1
    s_lshr_b32 s54, s52, 1
    s_mul_i32 s61, s61, 2
    s_and_b32 s3, s57, 6
    s_add_u32 s70, s61, s3
    s_sub_u32 s3, s70, 9
    s_cselect_b32 s70, s70, s3
    s_add_u32 s71, s70, 1
    s_cmp_eq_u32 s71, 9
    s_cselect_b32 s71, 0, s71
    s_add_u32 s72, s71, 1
    s_cmp_eq_u32 s72, 9
    s_cselect_b32 s72, 0, s72
    s_add_u32 s73, s72, 1
    s_cmp_eq_u32 s73, 9
    s_cselect_b32 s73, 0, s73
    s_add_u32 s74, s73, 1
    s_cmp_eq_u32 s74, 9
    s_cselect_b32 s74, 0, s74
    s_add_u32 s75, s74, 1
    s_cmp_eq_u32 s75, 9
    s_cselect_b32 s75, 0, s75
    s_add_u32 s76, s75, 1
    s_cmp_eq_u32 s76, 9
    s_cselect_b32 s76, 0, s76
    s_add_u32 s77, s76, 1
    s_cmp_eq_u32 s77, 9
    s_cselect_b32 s77, 0, s77
    s_add_u32 s78, s77, 1
    s_cmp_eq_u32 s78, 9
    s_cselect_b32 s78, 0, s78
    v_and_b32 v1, 15, v0
    v_lshrrev_b32 v2, 4, v0
    v_bfe_u32 v3, v0, 2, 2
    v_and_b32 v241, 3, v0
    v_lshrrev_b32 v242, 5, v0
    v_and_b32 v243, 31, v0
    s_lshl_b32 s3, s52, 3
    s_lshl_b32 s61, s53, 2
    v_add_u32 v244, 0, v242
    v_and_b32 v245, 3, v244
    v_or_b32 v245, s61, v245
    v_lshlrev_b32 v245, 1, v245
    v_xor_b32 v245, v245, v243
    v_add_u32 v244, s3, v244
    v_lshlrev_b32 v244, 13, v244
    v_lshl_add_u32 v234, v245, 4, v244
    v_add_u32 v244, 2, v242
    v_and_b32 v245, 3, v244
    v_or_b32 v245, s61, v245
    v_lshlrev_b32 v245, 1, v245
    v_xor_b32 v245, v245, v243
    v_add_u32 v244, s3, v244
    v_lshlrev_b32 v244, 13, v244
    v_lshl_add_u32 v235, v245, 4, v244
    v_subrev_u32 v235, 1024, v235
    v_add_u32 v244, 4, v242
    v_and_b32 v245, 3, v244
    v_or_b32 v245, s61, v245
    v_lshlrev_b32 v245, 1, v245
    v_xor_b32 v245, v245, v243
    v_add_u32 v244, s3, v244
    v_lshlrev_b32 v244, 13, v244
    v_lshl_add_u32 v236, v245, 4, v244
    v_subrev_u32 v236, 2048, v236
    v_add_u32 v244, 6, v242
    v_and_b32 v245, 3, v244
    v_or_b32 v245, s61, v245
    v_lshlrev_b32 v245, 1, v245
    v_xor_b32 v245, v245, v243
    v_add_u32 v244, s3, v244
    v_lshlrev_b32 v244, 13, v244
    v_lshl_add_u32 v237, v245, 4, v244
    v_subrev_u32 v237, 3072, v237
    v_lshrrev_b32 v242, 3, v0
    v_and_b32 v243, 7, v0
    s_mul_i32 s3, s52, 24
    s_movk_i32 s61, 1152
    v_add_u32 v244, s3, v242
    v_bfe_u32 v245, v244, 1, 3
    v_xor_b32 v245, v245, v243
    v_mul_lo_u32 v244, v244, s61
    v_lshl_add_u32 v238, v245, 4, v244
    v_add_u32 v244, s3, v242
    v_add_u32 v244, 8, v244
    v_bfe_u32 v245, v244, 1, 3
    v_xor_b32 v245, v245, v243
    v_mul_lo_u32 v244, v244, s61
    v_lshl_add_u32 v239, v245, 4, v244
    v_subrev_u32 v239, 1024, v239
    v_add_u32 v244, s3, v242
    v_add_u32 v244, 16, v244
    v_bfe_u32 v245, v244, 1, 3
    v_xor_b32 v245, v245, v243
    v_mul_lo_u32 v244, v244, s61
    v_lshl_add_u32 v240, v245, 4, v244
    v_subrev_u32 v240, 2048, v240
    s_waitcnt lgkmcnt(0)
    s_cmp_eq_u32 s55, 0
    s_cselect_b32 s4, s4, s14
    s_cselect_b32 s5, s5, s15
    s_cselect_b32 s6, s6, s16
    s_cselect_b32 s7, s7, s17
    s_cselect_b32 s8, s8, s18
    s_cselect_b32 s9, s9, s19
    s_cselect_b32 s10, s10, s20
    s_cselect_b32 s11, s11, s21
    s_mul_i32 s3, s57, 110592
    s_add_u32 s4, s4, s3
    s_addc_u32 s5, s5, 0
    s_mov_b32 s32, s4
    s_and_b32 s33, s5, 0xffff
    s_mov_b32 s34, 110592
    s_mov_b32 s35, 0x20000
    s_lshl_b32 s3, s56, 9
    s_add_u32 s10, s10, s3
    s_addc_u32 s11, s11, 0
    s_mov_b32 s36, s10
    s_and_b32 s37, s11, 0xffff
    s_mov_b32 s38, 4718592
    s_mov_b32 s39, 0x20000
    s_sub_u32 s38, s38, s3
    s_lshl_b32 s62, s52, 12
    s_add_u32 s62, s62, 65536
    s_mul_i32 s63, s52, 3072
    s_add_u32 s63, s63, 131072
    s_add_u32 s30, s28, 16777216
    s_addc_u32 s31, s29, 0
    s_mov_b32 s80, s30
    s_and_b32 s81, s31, 0xffff
    s_mov_b32 s82, 65536
    s_mov_b32 s83, 0x20000
    s_mov_b32 s84, s26
    s_and_b32 s85, s27, 0xffff
    s_mov_b32 s86, 256
    s_mov_b32 s87, 0x20000
    s_add_u32 m0, s63, 0
    s_lshl_b32 s65, s70, 7
    buffer_load_dwordx4 v238, s[32:35], s65 offen offset:0 lds
    buffer_load_dwordx4 v239, s[32:35], s65 offen offset:1024 lds
    buffer_load_dwordx4 v240, s[32:35], s65 offen offset:2048 lds
    s_add_u32 m0, s62, 0
    s_lshl_b32 s64, s70, 19
    buffer_load_dwordx4 v234, s[36:39], s64 offen offset:0 lds
    buffer_load_dwordx4 v235, s[36:39], s64 offen offset:1024 lds
    buffer_load_dwordx4 v236, s[36:39], s64 offen offset:2048 lds
    buffer_load_dwordx4 v237, s[36:39], s64 offen offset:3072 lds
    s_getpc_b64 s[30:31]
L1_pc:
    s_lshr_b32 s3, s2, 3
    s_lshl_b32 s3, s3, 2
    s_add_u32 s3, s3, s52
    s_lshl_b32 s3, s3, 8
    v_and_b32 v246, 1, v0
    v_lshlrev_b32 v246, 7, v246
    v_add_u32 v246, s3, v246
    v_min_u32 v246, L1_slow-L1_pc, v246
    v_mov_b32 v247, s31
    v_add_co_u32 v246, vcc, s30, v246
    s_nop 1
    v_addc_co_u32 v247, vcc, 0, v247, vcc
    global_load_dword v249, v[246:247], off
    s_lshl_b32 s31, s55, 3
    s_add_u32 s31, s31, s57
    s_lshl_b32 s31, s31, 4
    s_add_u32 s31, s31, s56
    s_lshl_b32 s31, s31, 7
    v_mov_b32 v250, 0
    s_lshl_b32 s30, s2, 7
    s_add_u32 s30, s30, 0x8000
    s_cmp_lg_u32 s52, 0
    s_cbranch_scc1 L1_clr
    s_mov_b64 exec, 1
    buffer_store_dword v250, off, s[80:83], s31 sc1
    buffer_store_dword v250, off, s[80:83], s30 sc1
    s_mov_b64 exec, -1
L1_clr:
    s_add_u32 m0, s62, 16384
    s_lshl_b32 s64, s70, 19
    s_add_u32 s64, s64, 262144
    buffer_load_dwordx4 v234, s[36:39], s64 offen offset:0 lds
    buffer_load_dwordx4 v235, s[36:39], s64 offen offset:1024 lds
    buffer_load_dwordx4 v236, s[36:39], s64 offen offset:2048 lds
    buffer_load_dwordx4 v237, s[36:39], s64 offen offset:3072 lds
    s_lshl_b32 s3, s57, 4
    s_add_u32 s3, s3, s56
    s_lshl_b32 s3, s3, 18
    s_add_u32 s6, s6, s3
    s_addc_u32 s7, s7, 0
    s_add_u32 s8, s8, s3
    s_addc_u32 s9, s9, 0
    s_mov_b32 s40, s6
    s_and_b32 s41, s7, 0xffff
    s_mov_b32 s42, 262144
    s_mov_b32 s43, 0x20000
    s_mov_b32 s44, s8
    s_and_b32 s45, s9, 0xffff
    s_mov_b32 s46, 262144
    s_mov_b32 s47, 0x20000
    s_lshl_b32 s59, s52, 11
    s_lshl_b32 s3, s55, 3
    s_add_u32 s3, s3, s57
    s_mul_i32 s3, s3, 786432
    s_mul_i32 s61, s54, 393216
    s_add_u32 s3, s3, s61
    s_lshl_b32 s61, s56, 1
    s_add_u32 s61, s61, s53
    s_lshl_b32 s61, s61, 12
    s_add_u32 s3, s3, s61
    s_add_u32 s30, s28, s3
    s_addc_u32 s31, s29, 0
    s_mov_b32 s48, s30
    s_and_b32 s49, s31, 0xffff
    s_mov_b32 s50, 266240
    s_mov_b32 s51, 0x20000
    s_lshl_b32 s3, s52, 3
    v_add_u32 v242, s3, v2
    v_and_b32 v243, 15, v242
    v_xor_b32 v243, v243, v1
    v_lshlrev_b32 v244, 8, v242
    v_lshl_add_u32 v220, v243, 4, v244
    v_and_b32 v243, 7, v242
    v_lshlrev_b32 v243, 1, v243
    v_xor_b32 v243, v243, v1
    v_lshl_add_u32 v222, v243, 4, v244
    v_add_u32 v242, s3, v2
    v_add_u32 v242, 4, v242
    v_and_b32 v243, 15, v242
    v_xor_b32 v243, v243, v1
    v_lshlrev_b32 v244, 8, v242
    v_subrev_u32 v244, 1024, v244
    v_lshl_add_u32 v221, v243, 4, v244
    v_and_b32 v243, 7, v242
    v_lshlrev_b32 v243, 1, v243
    v_xor_b32 v243, v243, v1
    v_lshl_add_u32 v223, v243, 4, v244
    v_lshl_add_u32 v242, v2, 3, v3
    v_lshlrev_b32 v242, 9, v242
    v_and_b32 v243, 1, v241
    v_lshl_add_u32 v242, v243, 3, v242
    s_lshl_b32 s3, s53, 8
    s_add_u32 s3, s3, 65536
    v_add_u32 v242, s3, v242
    v_and_b32 v243, 1, v2
    v_lshl_add_u32 v243, v243, 2, v3
    v_lshrrev_b32 v244, 1, v241
    v_and_b32 v244, 1, v241
    v_lshlrev_b32 v244, 3, v244
    v_sub_u32 v242, v242, v244
    v_lshlrev_b32 v243, 1, v243
    v_add_u32 v245, 0, v241
    v_xor_b32 v245, v245, v243
    v_lshl_add_u32 v224, v245, 4, v242
    v_add_u32 v245, 0, v241
    v_xor_b32 v245, v245, v243
    v_lshl_add_u32 v225, v245, 4, v242
    v_add_u32 v225, 8, v225
    v_add_u32 v245, 4, v241
    v_xor_b32 v245, v245, v243
    v_lshl_add_u32 v226, v245, 4, v242
    v_add_u32 v245, 4, v241
    v_xor_b32 v245, v245, v243
    v_lshl_add_u32 v227, v245, 4, v242
    v_add_u32 v227, 8, v227
    v_add_u32 v245, 8, v241
    v_xor_b32 v245, v245, v243
    v_lshl_add_u32 v228, v245, 4, v242
    v_add_u32 v245, 8, v241
    v_xor_b32 v245, v245, v243
    v_lshl_add_u32 v229, v245, 4, v242
    v_add_u32 v229, 8, v229
    v_add_u32 v245, 12, v241
    v_xor_b32 v245, v245, v243
    v_lshl_add_u32 v230, v245, 4, v242
    v_add_u32 v245, 12, v241
    v_xor_b32 v245, v245, v243
    v_lshl_add_u32 v231, v245, 4, v242
    v_add_u32 v231, 8, v231
    s_mul_i32 s3, s54, 6144
    s_add_u32 s3, s3, 131072
    v_lshlrev_b32 v242, 7, v1
    v_add_u32 v242, s3, v242
    v_lshrrev_b32 v243, 1, v1
    v_add_u32 v244, 0, v2
    v_xor_b32 v244, v244, v243
    v_lshl_add_u32 v232, v244, 4, v242
    v_add_u32 v244, 4, v2
    v_xor_b32 v244, v244, v243
    v_lshl_add_u32 v233, v244, 4, v242
    v_lshlrev_b32 v242, 8, v1
    v_add_u32 v244, 0, v2
    v_xor_b32 v244, v244, v1
    v_lshl_add_u32 v4, v244, 4, v242
    v_add_u32 v244, 4, v2
    v_xor_b32 v244, v244, v1
    v_lshl_add_u32 v5, v244, 4, v242
    v_add_u32 v244, 8, v2
    v_xor_b32 v244, v244, v1
    v_lshl_add_u32 v6, v244, 4, v242
    v_add_u32 v244, 12, v2
    v_xor_b32 v244, v244, v1
    v_lshl_add_u32 v7, v244, 4, v242
    v_lshl_add_u32 v242, v2, 2, v3
    v_and_b32 v243, 7, v242
    v_lshlrev_b32 v242, 8, v242
    v_and_b32 v245, 1, v241
    v_lshl_add_u32 v242, v245, 3, v242
    v_add_u32 v242, 0x8000, v242
    v_lshrrev_b32 v244, 1, v241
    v_xor_b32 v245, 0, v243
    v_lshl_add_u32 v245, v245, 1, v244
    v_lshl_add_u32 v8, v245, 4, v242
    v_xor_b32 v245, 1, v243
    v_lshl_add_u32 v245, v245, 1, v244
    v_lshl_add_u32 v9, v245, 4, v242
    v_xor_b32 v245, 2, v243
    v_lshl_add_u32 v245, v245, 1, v244
    v_lshl_add_u32 v10, v245, 4, v242
    v_xor_b32 v245, 3, v243
    v_lshl_add_u32 v245, v245, 1, v244
    v_lshl_add_u32 v11, v245, 4, v242
    v_xor_b32 v245, 4, v243
    v_lshl_add_u32 v245, v245, 1, v244
    v_lshl_add_u32 v12, v245, 4, v242
    v_xor_b32 v245, 5, v243
    v_lshl_add_u32 v245, v245, 1, v244
    v_lshl_add_u32 v13, v245, 4, v242
    v_xor_b32 v245, 6, v243
    v_lshl_add_u32 v245, v245, 1, v244
    v_lshl_add_u32 v14, v245, 4, v242
    v_xor_b32 v245, 7, v243
    v_lshl_add_u32 v245, v245, 1, v244
    v_lshl_add_u32 v15, v245, 4, v242
    v_mov_b32 v242, 0x3f803f80
    v_accvgpr_write_b32 a64, v242
    v_accvgpr_write_b32 a65, v242
    v_accvgpr_write_b32 a66, v242
    v_accvgpr_write_b32 a67, v242
    s_lshr_b32 s61, s2, 3
    s_bfe_u32 s92, s2, 0x10001
    s_and_b32 s31, s2, 1
    s_mul_i32 s30, s61, 43
    s_lshr_b32 s30, s30, 8
    s_mul_i32 s3, s30, 6
    s_sub_u32 s4, s61, s3
    s_mul_i32 s5, s31, 5
    s_add_u32 s5, s5, s30
    s_mul_i32 s31, s31, 3
    s_add_u32 s31, s31, s4
    s_lshl_b32 s6, s4, 1
    s_cmp_eq_u32 s30, 4
    s_cselect_b32 s5, 4, s5
    s_cselect_b32 s6, s6, s4
    s_cselect_b32 s4, s31, s4
    s_mul_i32 s6, s6, 171
    s_lshr_b32 s6, s6, 6
    s_mul_i32 s30, s30, 0
    s_add_u32 s6, s6, s30
    s_cmp_ge_u32 s61, 27
    s_cselect_b32 s5, 0, s5
    s_cselect_b32 s4, 0, s4
    s_cselect_b32 s7, 1, 0
    s_cmp_eq_u32 s55, 0
    s_cselect_b32 s12, s12, s22
    s_cselect_b32 s13, s13, s23
    s_lshl_b32 s3, s5, 7
    s_add_u32 s12, s12, s3
    s_addc_u32 s13, s13, 0
    s_mov_b32 s16, s12
    s_and_b32 s17, s13, 0xffff
    s_mov_b32 s18, 4718592
    s_mov_b32 s19, 0x20000
    s_sub_u32 s18, s18, s3
    s_mul_i32 s3, s55, 6
    s_add_u32 s3, s3, s4
    s_lshl_b32 s3, s3, 20
    s_add_u32 s30, s28, s3
    s_addc_u32 s31, s29, 0
    s_mov_b32 s20, s30
    s_and_b32 s21, s31, 0xffff
    s_mov_b32 s22, 1048576
    s_mov_b32 s23, 0x20000
    s_lshl_b32 s13, s92, 19
    s_xor_b32 s12, s13, 524288
    s_lshl_b32 s3, s92, 2
    s_add_u32 s3, s3, s52
    s_mul_i32 s8, s3, 589824
    s_mul_i32 s9, s52, 24576
    s_add_u32 s9, s9, 65536
    s_lshl_b32 s10, s52, 14
    v_lshrrev_b32 v243, 3, v0
    v_mul_u32_u24 v243, 1152, v243
    v_lshrrev_b32 v244, 4, v0
    v_lshlrev_b32 v244, 1, v244
    v_and_b32 v245, 7, v0
    v_xor_b32 v244, v244, v245
    v_lshl_add_u32 v48, v244, 4, v243
    v_add_u32 v49, 8192, v48
    v_add_u32 v50, 16384, v48
    v_add_u32 v51, 24576, v48
    s_lshl_b32 s30, s3, 14
    v_lshlrev_b32 v52, 4, v0
    v_add_u32 v52, s30, v52
    s_add_u32 s30, s52, 3
    s_and_b32 s30, s30, 3
    s_lshl_b32 s30, s30, 17
    v_add_u32 v55, s30, v52
    s_add_u32 s30, s52, 2
    s_and_b32 s30, s30, 3
    s_lshl_b32 s30, s30, 17
    v_add_u32 v54, s30, v52
    s_add_u32 s30, s52, 1
    s_and_b32 s30, s30, 3
    s_lshl_b32 s30, s30, 17
    v_add_u32 v53, s30, v52
    s_add_u32 s30, s52, 0
    s_and_b32 s30, s30, 3
    s_lshl_b32 s30, s30, 17
    v_add_u32 v52, s30, v52
    v_lshrrev_b32 v243, 2, v0
    v_bfe_u32 v244, v0, 3, 2
    v_lshlrev_b32 v243, 7, v243
    v_and_b32 v245, 1, v0
    v_lshl_add_u32 v243, v245, 3, v243
    v_bfe_u32 v245, v0, 1, 1
    v_xor_b32 v246, 0, v244
    v_lshl_add_u32 v246, v246, 1, v245
    v_lshl_add_u32 v246, v246, 4, v243
    v_add_u32 v40, s9, v246
    v_add_u32 v44, s10, v246
    v_xor_b32 v246, 1, v244
    v_lshl_add_u32 v246, v246, 1, v245
    v_lshl_add_u32 v246, v246, 4, v243
    v_add_u32 v41, s9, v246
    v_add_u32 v45, s10, v246
    v_xor_b32 v246, 2, v244
    v_lshl_add_u32 v246, v246, 1, v245
    v_lshl_add_u32 v246, v246, 4, v243
    v_add_u32 v42, s9, v246
    v_add_u32 v46, s10, v246
    v_xor_b32 v246, 3, v244
    v_lshl_add_u32 v246, v246, 1, v245
    v_lshl_add_u32 v246, v246, 4, v243
    v_add_u32 v43, s9, v246
    v_add_u32 v47, s10, v246
    s_cmp_eq_u32 s7, 0
    s_cselect_b32 s18, s18, 0
    v_accvgpr_write_b32 a68, v40
    v_accvgpr_write_b32 a69, v41
    v_accvgpr_write_b32 a70, v42
    v_accvgpr_write_b32 a71, v43
    v_accvgpr_write_b32 a72, v44
    v_accvgpr_write_b32 a73, v45
    v_accvgpr_write_b32 a74, v46
    v_accvgpr_write_b32 a75, v47
    v_accvgpr_write_b32 a76, v48
    v_accvgpr_write_b32 a77, v49
    v_accvgpr_write_b32 a78, v50
    v_accvgpr_write_b32 a79, v51
    v_accvgpr_write_b32 a80, v52
    v_accvgpr_write_b32 a81, v53
    v_accvgpr_write_b32 a82, v54
    v_accvgpr_write_b32 a83, v55
    s_waitcnt vmcnt(5)
    s_barrier
    ds_read_b128 v[16:19], v232 offset:0
    ds_read_b128 v[20:23], v232 offset:2048
    ds_read_b128 v[24:27], v232 offset:4096
    ds_read_b64_tr_b16 a[0:1], v224 offset:0
    ds_read_b64_tr_b16 a[2:3], v224 offset:2048
    ds_read_b64_tr_b16 a[4:5], v225 offset:0
    ds_read_b64_tr_b16 a[6:7], v225 offset:2048
    ds_read_b64_tr_b16 a[8:9], v226 offset:0
    ds_read_b64_tr_b16 a[10:11], v226 offset:2048
    ds_read_b64_tr_b16 a[12:13], v227 offset:0
    ds_read_b64_tr_b16 a[14:15], v227 offset:2048
    ds_read_b64_tr_b16 a[16:17], v228 offset:0
    ds_read_b64_tr_b16 a[18:19], v228 offset:2048
    ds_read_b64_tr_b16 a[20:21], v229 offset:0
    ds_read_b64_tr_b16 a[22:23], v229 offset:2048
    ds_read_b64_tr_b16 a[24:25], v230 offset:0
    ds_read_b64_tr_b16 a[26:27], v230 offset:2048
    ds_read_b64_tr_b16 a[28:29], v231 offset:0
    ds_read_b64_tr_b16 a[30:31], v231 offset:2048
    s_add_u32 m0, s63, 12288
    s_lshl_b32 s65, s71, 7
    buffer_load_dwordx4 v238, s[32:35], s65 offen offset:0 lds
    buffer_load_dwordx4 v239, s[32:35], s65 offen offset:1024 lds
    buffer_load_dwordx4 v240, s[32:35], s65 offen offset:2048 lds
    s_add_u32 m0, s62, 32768
    s_lshl_b32 s64, s71, 19
    buffer_load_dwordx4 v234, s[36:39], s64 offen offset:0 lds
    buffer_load_dwordx4 v235, s[36:39], s64 offen offset:1024 lds
    buffer_load_dwordx4 v236, s[36:39], s64 offen offset:2048 lds
    buffer_load_dwordx4 v237, s[36:39], s64 offen offset:3072 lds
    s_waitcnt vmcnt(7) lgkmcnt(0)
    s_barrier
    v_mfma_f32_16x16x32_bf16 v[64:67], a[0:3], v[16:19], 0
    ds_read_b128 v[28:31], v233 offset:0
    v_mfma_f32_16x16x32_bf16 v[96:99], a[0:3], v[20:23], 0
    ds_read_b128 v[32:35], v233 offset:2048
    s_add_u32 m0, s62, 49152
    s_lshl_b32 s64, s71, 19
    s_add_u32 s64, s64, 262144
    buffer_load_dwordx4 v234, s[36:39], s64 offen offset:0 lds
    v_mfma_f32_16x16x32_bf16 v[128:131], a[0:3], v[24:27], 0
    ds_read_b128 v[36:39], v233 offset:4096
    v_mfma_f32_16x16x32_bf16 v[68:71], a[4:7], v[16:19], 0
    ds_read_b64_tr_b16 a[32:33], v224 offset:16384
    buffer_load_dwordx4 v235, s[36:39], s64 offen offset:1024 lds
    v_mfma_f32_16x16x32_bf16 v[100:103], a[4:7], v[20:23], 0
    ds_read_b64_tr_b16 a[34:35], v224 offset:18432
    v_mfma_f32_16x16x32_bf16 v[132:135], a[4:7], v[24:27], 0
    ds_read_b64_tr_b16 a[36:37], v225 offset:16384
    v_mfma_f32_16x16x32_bf16 v[72:75], a[8:11], v[16:19], 0
    ds_read_b64_tr_b16 a[38:39], v225 offset:18432
    buffer_load_dwordx4 v236, s[36:39], s64 offen offset:2048 lds
    v_mfma_f32_16x16x32_bf16 v[104:107], a[8:11], v[20:23], 0
    ds_read_b64_tr_b16 a[40:41], v226 offset:16384
    v_mfma_f32_16x16x32_bf16 v[136:139], a[8:11], v[24:27], 0
    ds_read_b64_tr_b16 a[42:43], v226 offset:18432
    v_mfma_f32_16x16x32_bf16 v[76:79], a[12:15], v[16:19], 0
    ds_read_b64_tr_b16 a[44:45], v227 offset:16384
    buffer_load_dwordx4 v237, s[36:39], s64 offen offset:3072 lds
    v_mfma_f32_16x16x32_bf16 v[108:111], a[12:15], v[20:23], 0
    ds_read_b64_tr_b16 a[46:47], v227 offset:18432
    v_mfma_f32_16x16x32_bf16 v[140:143], a[12:15], v[24:27], 0
    ds_read_b64_tr_b16 a[48:49], v228 offset:16384
    v_mfma_f32_16x16x32_bf16 v[80:83], a[16:19], v[16:19], 0
    ds_read_b64_tr_b16 a[50:51], v228 offset:18432
    s_add_u32 m0, s62, 0
    s_lshl_b32 s64, s72, 19
    buffer_load_dwordx4 v234, s[36:39], s64 offen offset:0 lds
    v_mfma_f32_16x16x32_bf16 v[112:115], a[16:19], v[20:23], 0
    ds_read_b64_tr_b16 a[52:53], v229 offset:16384
    v_mfma_f32_16x16x32_bf16 v[144:147], a[16:19], v[24:27], 0
    ds_read_b64_tr_b16 a[54:55], v229 offset:18432
    v_mfma_f32_16x16x32_bf16 v[84:87], a[20:23], v[16:19], 0
    ds_read_b64_tr_b16 a[56:57], v230 offset:16384
    buffer_load_dwordx4 v235, s[36:39], s64 offen offset:1024 lds
    v_mfma_f32_16x16x32_bf16 v[116:119], a[20:23], v[20:23], 0
    ds_read_b64_tr_b16 a[58:59], v230 offset:18432
    v_mfma_f32_16x16x32_bf16 v[148:151], a[20:23], v[24:27], 0
    ds_read_b64_tr_b16 a[60:61], v231 offset:16384
    v_mfma_f32_16x16x32_bf16 v[88:91], a[24:27], v[16:19], 0
    ds_read_b64_tr_b16 a[62:63], v231 offset:18432
    buffer_load_dwordx4 v236, s[36:39], s64 offen offset:2048 lds
    v_mfma_f32_16x16x32_bf16 v[120:123], a[24:27], v[20:23], 0
    v_mfma_f32_16x16x32_bf16 v[152:155], a[24:27], v[24:27], 0
    v_mfma_f32_16x16x32_bf16 v[92:95], a[28:31], v[16:19], 0
    buffer_load_dwordx4 v237, s[36:39], s64 offen offset:3072 lds
    v_mfma_f32_16x16x32_bf16 v[124:127], a[28:31], v[20:23], 0
    v_mfma_f32_16x16x32_bf16 v[156:159], a[28:31], v[24:27], 0
    s_waitcnt vmcnt(8) lgkmcnt(0)
    s_barrier
    v_mfma_f32_16x16x32_bf16 v[64:67], a[32:35], v[28:31], v[64:67]
    ds_read_b128 v[16:19], v232 offset:12288
    v_mfma_f32_16x16x32_bf16 v[96:99], a[32:35], v[32:35], v[96:99]
    ds_read_b128 v[20:23], v232 offset:14336
    v_mfma_f32_16x16x32_bf16 v[128:131], a[32:35], v[36:39], v[128:131]
    ds_read_b128 v[24:27], v232 offset:16384
    v_mfma_f32_16x16x32_bf16 v[68:71], a[36:39], v[28:31], v[68:71]
    ds_read_b64_tr_b16 a[0:1], v224 offset:32768
    s_add_u32 m0, s63, 0
    s_lshl_b32 s65, s72, 7
    buffer_load_dwordx4 v238, s[32:35], s65 offen offset:0 lds
    v_mfma_f32_16x16x32_bf16 v[100:103], a[36:39], v[32:35], v[100:103]
    ds_read_b64_tr_b16 a[2:3], v224 offset:34816
    v_mfma_f32_16x16x32_bf16 v[132:135], a[36:39], v[36:39], v[132:135]
    ds_read_b64_tr_b16 a[4:5], v225 offset:32768
    v_mfma_f32_16x16x32_bf16 v[72:75], a[40:43], v[28:31], v[72:75]
    ds_read_b64_tr_b16 a[6:7], v225 offset:34816
    v_mfma_f32_16x16x32_bf16 v[104:107], a[40:43], v[32:35], v[104:107]
    ds_read_b64_tr_b16 a[8:9], v226 offset:32768
    buffer_load_dwordx4 v239, s[32:35], s65 offen offset:1024 lds
    v_mfma_f32_16x16x32_bf16 v[136:139], a[40:43], v[36:39], v[136:139]
    ds_read_b64_tr_b16 a[10:11], v226 offset:34816
    v_mfma_f32_16x16x32_bf16 v[76:79], a[44:47], v[28:31], v[76:79]
    ds_read_b64_tr_b16 a[12:13], v227 offset:32768
    v_mfma_f32_16x16x32_bf16 v[108:111], a[44:47], v[32:35], v[108:111]
    ds_read_b64_tr_b16 a[14:15], v227 offset:34816
    v_mfma_f32_16x16x32_bf16 v[140:143], a[44:47], v[36:39], v[140:143]
    ds_read_b64_tr_b16 a[16:17], v228 offset:32768
    buffer_load_dwordx4 v240, s[32:35], s65 offen offset:2048 lds
    v_mfma_f32_16x16x32_bf16 v[80:83], a[48:51], v[28:31], v[80:83]
    ds_read_b64_tr_b16 a[18:19], v228 offset:34816
    v_mfma_f32_16x16x32_bf16 v[112:115], a[48:51], v[32:35], v[112:115]
    ds_read_b64_tr_b16 a[20:21], v229 offset:32768
    v_mfma_f32_16x16x32_bf16 v[144:147], a[48:51], v[36:39], v[144:147]
    ds_read_b64_tr_b16 a[22:23], v229 offset:34816
    v_mfma_f32_16x16x32_bf16 v[84:87], a[52:55], v[28:31], v[84:87]
    ds_read_b64_tr_b16 a[24:25], v230 offset:32768
    s_add_u32 m0, s62, 16384
    s_lshl_b32 s64, s72, 19
    s_add_u32 s64, s64, 262144
    buffer_load_dwordx4 v234, s[36:39], s64 offen offset:0 lds
    v_mfma_f32_16x16x32_bf16 v[116:119], a[52:55], v[32:35], v[116:119]
    ds_read_b64_tr_b16 a[26:27], v230 offset:34816
    v_mfma_f32_16x16x32_bf16 v[148:151], a[52:55], v[36:39], v[148:151]
    ds_read_b64_tr_b16 a[28:29], v231 offset:32768
    v_mfma_f32_16x16x32_bf16 v[88:91], a[56:59], v[28:31], v[88:91]
    ds_read_b64_tr_b16 a[30:31], v231 offset:34816
    v_mfma_f32_16x16x32_bf16 v[120:123], a[56:59], v[32:35], v[120:123]
    buffer_load_dwordx4 v235, s[36:39], s64 offen offset:1024 lds
    v_mfma_f32_16x16x32_bf16 v[152:155], a[56:59], v[36:39], v[152:155]
    v_mfma_f32_16x16x32_bf16 v[92:95], a[60:63], v[28:31], v[92:95]
    buffer_load_dwordx4 v236, s[36:39], s64 offen offset:2048 lds
    v_mfma_f32_16x16x32_bf16 v[124:127], a[60:63], v[32:35], v[124:127]
    v_mfma_f32_16x16x32_bf16 v[156:159], a[60:63], v[36:39], v[156:159]
    buffer_load_dwordx4 v237, s[36:39], s64 offen offset:3072 lds
    s_waitcnt vmcnt(11) lgkmcnt(0)
    s_barrier
    v_mfma_f32_16x16x32_bf16 v[64:67], a[0:3], v[16:19], v[64:67]
    ds_read_b128 v[28:31], v233 offset:12288
    v_mfma_f32_16x16x32_bf16 v[96:99], a[0:3], v[20:23], v[96:99]
    ds_read_b128 v[32:35], v233 offset:14336
    v_mfma_f32_16x16x32_bf16 v[128:131], a[0:3], v[24:27], v[128:131]
    ds_read_b128 v[36:39], v233 offset:16384
    v_mfma_f32_16x16x32_bf16 v[68:71], a[4:7], v[16:19], v[68:71]
    ds_read_b64_tr_b16 a[32:33], v224 offset:49152
    s_add_u32 m0, s62, 32768
    s_lshl_b32 s64, s73, 19
    buffer_load_dwordx4 v234, s[36:39], s64 offen offset:0 lds
    v_mfma_f32_16x16x32_bf16 v[100:103], a[4:7], v[20:23], v[100:103]
    ds_read_b64_tr_b16 a[34:35], v224 offset:51200
    v_mfma_f32_16x16x32_bf16 v[132:135], a[4:7], v[24:27], v[132:135]
    ds_read_b64_tr_b16 a[36:37], v225 offset:49152
    v_mfma_f32_16x16x32_bf16 v[72:75], a[8:11], v[16:19], v[72:75]
    ds_read_b64_tr_b16 a[38:39], v225 offset:51200
    v_mfma_f32_16x16x32_bf16 v[104:107], a[8:11], v[20:23], v[104:107]
    ds_read_b64_tr_b16 a[40:41], v226 offset:49152
    v_mfma_f32_16x16x32_bf16 v[136:139], a[8:11], v[24:27], v[136:139]
    ds_read_b64_tr_b16 a[42:43], v226 offset:51200
    v_mfma_f32_16x16x32_bf16 v[76:79], a[12:15], v[16:19], v[76:79]
    ds_read_b64_tr_b16 a[44:45], v227 offset:49152
    buffer_load_dwordx4 v235, s[36:39], s64 offen offset:1024 lds
    v_mfma_f32_16x16x32_bf16 v[108:111], a[12:15], v[20:23], v[108:111]
    ds_read_b64_tr_b16 a[46:47], v227 offset:51200
    v_mfma_f32_16x16x32_bf16 v[140:143], a[12:15], v[24:27], v[140:143]
    ds_read_b64_tr_b16 a[48:49], v228 offset:49152
    v_mfma_f32_16x16x32_bf16 v[80:83], a[16:19], v[16:19], v[80:83]
    ds_read_b64_tr_b16 a[50:51], v228 offset:51200
    v_mfma_f32_16x16x32_bf16 v[112:115], a[16:19], v[20:23], v[112:115]
    ds_read_b64_tr_b16 a[52:53], v229 offset:49152
    v_mfma_f32_16x16x32_bf16 v[144:147], a[16:19], v[24:27], v[144:147]
    ds_read_b64_tr_b16 a[54:55], v229 offset:51200
    v_mfma_f32_16x16x32_bf16 v[84:87], a[20:23], v[16:19], v[84:87]
    ds_read_b64_tr_b16 a[56:57], v230 offset:49152
    buffer_load_dwordx4 v236, s[36:39], s64 offen offset:2048 lds
    v_mfma_f32_16x16x32_bf16 v[116:119], a[20:23], v[20:23], v[116:119]
    ds_read_b64_tr_b16 a[58:59], v230 offset:51200
    v_mfma_f32_16x16x32_bf16 v[148:151], a[20:23], v[24:27], v[148:151]
    ds_read_b64_tr_b16 a[60:61], v231 offset:49152
    v_mfma_f32_16x16x32_bf16 v[88:91], a[24:27], v[16:19], v[88:91]
    ds_read_b64_tr_b16 a[62:63], v231 offset:51200
    v_mfma_f32_16x16x32_bf16 v[120:123], a[24:27], v[20:23], v[120:123]
    v_mfma_f32_16x16x32_bf16 v[152:155], a[24:27], v[24:27], v[152:155]
    v_mfma_f32_16x16x32_bf16 v[92:95], a[28:31], v[16:19], v[92:95]
    buffer_load_dwordx4 v237, s[36:39], s64 offen offset:3072 lds
    v_mfma_f32_16x16x32_bf16 v[124:127], a[28:31], v[20:23], v[124:127]
    v_mfma_f32_16x16x32_bf16 v[156:159], a[28:31], v[24:27], v[156:159]
    s_waitcnt vmcnt(8) lgkmcnt(0)
    s_barrier
    v_mfma_f32_16x16x32_bf16 v[64:67], a[32:35], v[28:31], v[64:67]
    ds_read_b128 v[16:19], v232 offset:0
    v_mfma_f32_16x16x32_bf16 v[96:99], a[32:35], v[32:35], v[96:99]
    ds_read_b128 v[20:23], v232 offset:2048
    v_mfma_f32_16x16x32_bf16 v[128:131], a[32:35], v[36:39], v[128:131]
    ds_read_b128 v[24:27], v232 offset:4096
    v_mfma_f32_16x16x32_bf16 v[68:71], a[36:39], v[28:31], v[68:71]
    ds_read_b64_tr_b16 a[0:1], v224 offset:0
    s_add_u32 m0, s63, 12288
    s_lshl_b32 s65, s73, 7
    buffer_load_dwordx4 v238, s[32:35], s65 offen offset:0 lds
    v_mfma_f32_16x16x32_bf16 v[100:103], a[36:39], v[32:35], v[100:103]
    ds_read_b64_tr_b16 a[2:3], v224 offset:2048
    v_mfma_f32_16x16x32_bf16 v[132:135], a[36:39], v[36:39], v[132:135]
    ds_read_b64_tr_b16 a[4:5], v225 offset:0
    v_mfma_f32_16x16x32_bf16 v[72:75], a[40:43], v[28:31], v[72:75]
    ds_read_b64_tr_b16 a[6:7], v225 offset:2048
    v_mfma_f32_16x16x32_bf16 v[104:107], a[40:43], v[32:35], v[104:107]
    ds_read_b64_tr_b16 a[8:9], v226 offset:0
    buffer_load_dwordx4 v239, s[32:35], s65 offen offset:1024 lds
    v_mfma_f32_16x16x32_bf16 v[136:139], a[40:43], v[36:39], v[136:139]
    ds_read_b64_tr_b16 a[10:11], v226 offset:2048
    v_mfma_f32_16x16x32_bf16 v[76:79], a[44:47], v[28:31], v[76:79]
    ds_read_b64_tr_b16 a[12:13], v227 offset:0
    v_mfma_f32_16x16x32_bf16 v[108:111], a[44:47], v[32:35], v[108:111]
    ds_read_b64_tr_b16 a[14:15], v227 offset:2048
    v_mfma_f32_16x16x32_bf16 v[140:143], a[44:47], v[36:39], v[140:143]
    ds_read_b64_tr_b16 a[16:17], v228 offset:0
    buffer_load_dwordx4 v240, s[32:35], s65 offen offset:2048 lds
    v_mfma_f32_16x16x32_bf16 v[80:83], a[48:51], v[28:31], v[80:83]
    ds_read_b64_tr_b16 a[18:19], v228 offset:2048
    v_mfma_f32_16x16x32_bf16 v[112:115], a[48:51], v[32:35], v[112:115]
    ds_read_b64_tr_b16 a[20:21], v229 offset:0
    v_mfma_f32_16x16x32_bf16 v[144:147], a[48:51], v[36:39], v[144:147]
    ds_read_b64_tr_b16 a[22:23], v229 offset:2048
    v_mfma_f32_16x16x32_bf16 v[84:87], a[52:55], v[28:31], v[84:87]
    ds_read_b64_tr_b16 a[24:25], v230 offset:0
    s_add_u32 m0, s62, 49152
    s_lshl_b32 s64, s73, 19
    s_add_u32 s64, s64, 262144
    buffer_load_dwordx4 v234, s[36:39], s64 offen offset:0 lds
    v_mfma_f32_16x16x32_bf16 v[116:119], a[52:55], v[32:35], v[116:119]
    ds_read_b64_tr_b16 a[26:27], v230 offset:2048
    v_mfma_f32_16x16x32_bf16 v[148:151], a[52:55], v[36:39], v[148:151]
    ds_read_b64_tr_b16 a[28:29], v231 offset:0
    v_mfma_f32_16x16x32_bf16 v[88:91], a[56:59], v[28:31], v[88:91]
    ds_read_b64_tr_b16 a[30:31], v231 offset:2048
    v_mfma_f32_16x16x32_bf16 v[120:123], a[56:59], v[32:35], v[120:123]
    buffer_load_dwordx4 v235, s[36:39], s64 offen offset:1024 lds
    v_mfma_f32_16x16x32_bf16 v[152:155], a[56:59], v[36:39], v[152:155]
    v_mfma_f32_16x16x32_bf16 v[92:95], a[60:63], v[28:31], v[92:95]
    buffer_load_dwordx4 v236, s[36:39], s64 offen offset:2048 lds
    v_mfma_f32_16x16x32_bf16 v[124:127], a[60:63], v[32:35], v[124:127]
    v_mfma_f32_16x16x32_bf16 v[156:159], a[60:63], v[36:39], v[156:159]
    buffer_load_dwordx4 v237, s[36:39], s64 offen offset:3072 lds
    s_waitcnt vmcnt(11) lgkmcnt(0)
    s_barrier
    v_mfma_f32_16x16x32_bf16 v[64:67], a[0:3], v[16:19], v[64:67]
    ds_read_b128 v[28:31], v233 offset:0
    v_mfma_f32_16x16x32_bf16 v[96:99], a[0:3], v[20:23], v[96:99]
    ds_read_b128 v[32:35], v233 offset:2048
    v_mfma_f32_16x16x32_bf16 v[128:131], a[0:3], v[24:27], v[128:131]
    ds_read_b128 v[36:39], v233 offset:4096
    v_mfma_f32_16x16x32_bf16 v[68:71], a[4:7], v[16:19], v[68:71]
    ds_read_b64_tr_b16 a[32:33], v224 offset:16384
    s_add_u32 m0, s62, 0
    s_lshl_b32 s64, s74, 19
    buffer_load_dwordx4 v234, s[36:39], s64 offen offset:0 lds
    v_mfma_f32_16x16x32_bf16 v[100:103], a[4:7], v[20:23], v[100:103]
    ds_read_b64_tr_b16 a[34:35], v224 offset:18432
    v_mfma_f32_16x16x32_bf16 v[132:135], a[4:7], v[24:27], v[132:135]
    ds_read_b64_tr_b16 a[36:37], v225 offset:16384
    v_mfma_f32_16x16x32_bf16 v[72:75], a[8:11], v[16:19], v[72:75]
    ds_read_b64_tr_b16 a[38:39], v225 offset:18432
    v_mfma_f32_16x16x32_bf16 v[104:107], a[8:11], v[20:23], v[104:107]
    ds_read_b64_tr_b16 a[40:41], v226 offset:16384
    v_mfma_f32_16x16x32_bf16 v[136:139], a[8:11], v[24:27], v[136:139]
    ds_read_b64_tr_b16 a[42:43], v226 offset:18432
    v_mfma_f32_16x16x32_bf16 v[76:79], a[12:15], v[16:19], v[76:79]
    ds_read_b64_tr_b16 a[44:45], v227 offset:16384
    buffer_load_dwordx4 v235, s[36:39], s64 offen offset:1024 lds
    v_mfma_f32_16x16x32_bf16 v[108:111], a[12:15], v[20:23], v[108:111]
    ds_read_b64_tr_b16 a[46:47], v227 offset:18432
    v_mfma_f32_16x16x32_bf16 v[140:143], a[12:15], v[24:27], v[140:143]
    ds_read_b64_tr_b16 a[48:49], v228 offset:16384
    v_mfma_f32_16x16x32_bf16 v[80:83], a[16:19], v[16:19], v[80:83]
    ds_read_b64_tr_b16 a[50:51], v228 offset:18432
    v_mfma_f32_16x16x32_bf16 v[112:115], a[16:19], v[20:23], v[112:115]
    ds_read_b64_tr_b16 a[52:53], v229 offset:16384
    v_mfma_f32_16x16x32_bf16 v[144:147], a[16:19], v[24:27], v[144:147]
    ds_read_b64_tr_b16 a[54:55], v229 offset:18432
    v_mfma_f32_16x16x32_bf16 v[84:87], a[20:23], v[16:19], v[84:87]
    ds_read_b64_tr_b16 a[56:57], v230 offset:16384
    buffer_load_dwordx4 v236, s[36:39], s64 offen offset:2048 lds
    v_mfma_f32_16x16x32_bf16 v[116:119], a[20:23], v[20:23], v[116:119]
    ds_read_b64_tr_b16 a[58:59], v230 offset:18432
    v_mfma_f32_16x16x32_bf16 v[148:151], a[20:23], v[24:27], v[148:151]
    ds_read_b64_tr_b16 a[60:61], v231 offset:16384
    v_mfma_f32_16x16x32_bf16 v[88:91], a[24:27], v[16:19], v[88:91]
    ds_read_b64_tr_b16 a[62:63], v231 offset:18432
    v_mfma_f32_16x16x32_bf16 v[120:123], a[24:27], v[20:23], v[120:123]
    v_mfma_f32_16x16x32_bf16 v[152:155], a[24:27], v[24:27], v[152:155]
    v_mfma_f32_16x16x32_bf16 v[92:95], a[28:31], v[16:19], v[92:95]
    buffer_load_dwordx4 v237, s[36:39], s64 offen offset:3072 lds
    v_mfma_f32_16x16x32_bf16 v[124:127], a[28:31], v[20:23], v[124:127]
    v_mfma_f32_16x16x32_bf16 v[156:159], a[28:31], v[24:27], v[156:159]
    s_waitcnt vmcnt(8) lgkmcnt(0)
    s_barrier
    v_mfma_f32_16x16x32_bf16 v[64:67], a[32:35], v[28:31], v[64:67]
    ds_read_b128 v[16:19], v232 offset:12288
    v_mfma_f32_16x16x32_bf16 v[96:99], a[32:35], v[32:35], v[96:99]
    ds_read_b128 v[20:23], v232 offset:14336
    v_mfma_f32_16x16x32_bf16 v[128:131], a[32:35], v[36:39], v[128:131]
    ds_read_b128 v[24:27], v232 offset:16384
    v_mfma_f32_16x16x32_bf16 v[68:71], a[36:39], v[28:31], v[68:71]
    ds_read_b64_tr_b16 a[0:1], v224 offset:32768
    s_add_u32 m0, s63, 0
    s_lshl_b32 s65, s74, 7
    buffer_load_dwordx4 v238, s[32:35], s65 offen offset:0 lds
    v_mfma_f32_16x16x32_bf16 v[100:103], a[36:39], v[32:35], v[100:103]
    ds_read_b64_tr_b16 a[2:3], v224 offset:34816
    v_mfma_f32_16x16x32_bf16 v[132:135], a[36:39], v[36:39], v[132:135]
    ds_read_b64_tr_b16 a[4:5], v225 offset:32768
    v_mfma_f32_16x16x32_bf16 v[72:75], a[40:43], v[28:31], v[72:75]
    ds_read_b64_tr_b16 a[6:7], v225 offset:34816
    v_mfma_f32_16x16x32_bf16 v[104:107], a[40:43], v[32:35], v[104:107]
    ds_read_b64_tr_b16 a[8:9], v226 offset:32768
    buffer_load_dwordx4 v239, s[32:35], s65 offen offset:1024 lds
    v_mfma_f32_16x16x32_bf16 v[136:139], a[40:43], v[36:39], v[136:139]
    ds_read_b64_tr_b16 a[10:11], v226 offset:34816
    v_mfma_f32_16x16x32_bf16 v[76:79], a[44:47], v[28:31], v[76:79]
    ds_read_b64_tr_b16 a[12:13], v227 offset:32768
    v_mfma_f32_16x16x32_bf16 v[108:111], a[44:47], v[32:35], v[108:111]
    ds_read_b64_tr_b16 a[14:15], v227 offset:34816
    v_mfma_f32_16x16x32_bf16 v[140:143], a[44:47], v[36:39], v[140:143]
    ds_read_b64_tr_b16 a[16:17], v228 offset:32768
    buffer_load_dwordx4 v240, s[32:35], s65 offen offset:2048 lds
    v_mfma_f32_16x16x32_bf16 v[80:83], a[48:51], v[28:31], v[80:83]
    ds_read_b64_tr_b16 a[18:19], v228 offset:34816
    v_mfma_f32_16x16x32_bf16 v[112:115], a[48:51], v[32:35], v[112:115]
    ds_read_b64_tr_b16 a[20:21], v229 offset:32768
    v_mfma_f32_16x16x32_bf16 v[144:147], a[48:51], v[36:39], v[144:147]
    ds_read_b64_tr_b16 a[22:23], v229 offset:34816
    v_mfma_f32_16x16x32_bf16 v[84:87], a[52:55], v[28:31], v[84:87]
    ds_read_b64_tr_b16 a[24:25], v230 offset:32768
    s_add_u32 m0, s62, 16384
    s_lshl_b32 s64, s74, 19
    s_add_u32 s64, s64, 262144
    buffer_load_dwordx4 v234, s[36:39], s64 offen offset:0 lds
    v_mfma_f32_16x16x32_bf16 v[116:119], a[52:55], v[32:35], v[116:119]
    ds_read_b64_tr_b16 a[26:27], v230 offset:34816
    v_mfma_f32_16x16x32_bf16 v[148:151], a[52:55], v[36:39], v[148:151]
    ds_read_b64_tr_b16 a[28:29], v231 offset:32768
    v_mfma_f32_16x16x32_bf16 v[88:91], a[56:59], v[28:31], v[88:91]
    ds_read_b64_tr_b16 a[30:31], v231 offset:34816
    v_mfma_f32_16x16x32_bf16 v[120:123], a[56:59], v[32:35], v[120:123]
    buffer_load_dwordx4 v235, s[36:39], s64 offen offset:1024 lds
    v_mfma_f32_16x16x32_bf16 v[152:155], a[56:59], v[36:39], v[152:155]
    v_mfma_f32_16x16x32_bf16 v[92:95], a[60:63], v[28:31], v[92:95]
    buffer_load_dwordx4 v236, s[36:39], s64 offen offset:2048 lds
    v_mfma_f32_16x16x32_bf16 v[124:127], a[60:63], v[32:35], v[124:127]
    v_mfma_f32_16x16x32_bf16 v[156:159], a[60:63], v[36:39], v[156:159]
    buffer_load_dwordx4 v237, s[36:39], s64 offen offset:3072 lds
    s_waitcnt vmcnt(11) lgkmcnt(0)
    s_barrier
    v_mfma_f32_16x16x32_bf16 v[64:67], a[0:3], v[16:19], v[64:67]
    ds_read_b128 v[28:31], v233 offset:12288
    v_mfma_f32_16x16x32_bf16 v[96:99], a[0:3], v[20:23], v[96:99]
    ds_read_b128 v[32:35], v233 offset:14336
    v_mfma_f32_16x16x32_bf16 v[128:131], a[0:3], v[24:27], v[128:131]
    ds_read_b128 v[36:39], v233 offset:16384
    v_mfma_f32_16x16x32_bf16 v[68:71], a[4:7], v[16:19], v[68:71]
    ds_read_b64_tr_b16 a[32:33], v224 offset:49152
    s_add_u32 m0, s62, 32768
    s_lshl_b32 s64, s75, 19
    buffer_load_dwordx4 v234, s[36:39], s64 offen offset:0 lds
    v_mfma_f32_16x16x32_bf16 v[100:103], a[4:7], v[20:23], v[100:103]
    ds_read_b64_tr_b16 a[34:35], v224 offset:51200
    v_mfma_f32_16x16x32_bf16 v[132:135], a[4:7], v[24:27], v[132:135]
    ds_read_b64_tr_b16 a[36:37], v225 offset:49152
    v_mfma_f32_16x16x32_bf16 v[72:75], a[8:11], v[16:19], v[72:75]
    ds_read_b64_tr_b16 a[38:39], v225 offset:51200
    v_mfma_f32_16x16x32_bf16 v[104:107], a[8:11], v[20:23], v[104:107]
    ds_read_b64_tr_b16 a[40:41], v226 offset:49152
    v_mfma_f32_16x16x32_bf16 v[136:139], a[8:11], v[24:27], v[136:139]
    ds_read_b64_tr_b16 a[42:43], v226 offset:51200
    v_mfma_f32_16x16x32_bf16 v[76:79], a[12:15], v[16:19], v[76:79]
    ds_read_b64_tr_b16 a[44:45], v227 offset:49152
    buffer_load_dwordx4 v235, s[36:39], s64 offen offset:1024 lds
    v_mfma_f32_16x16x32_bf16 v[108:111], a[12:15], v[20:23], v[108:111]
    ds_read_b64_tr_b16 a[46:47], v227 offset:51200
    v_mfma_f32_16x16x32_bf16 v[140:143], a[12:15], v[24:27], v[140:143]
    ds_read_b64_tr_b16 a[48:49], v228 offset:49152
    v_mfma_f32_16x16x32_bf16 v[80:83], a[16:19], v[16:19], v[80:83]
    ds_read_b64_tr_b16 a[50:51], v228 offset:51200
    v_mfma_f32_16x16x32_bf16 v[112:115], a[16:19], v[20:23], v[112:115]
    ds_read_b64_tr_b16 a[52:53], v229 offset:49152
    v_mfma_f32_16x16x32_bf16 v[144:147], a[16:19], v[24:27], v[144:147]
    ds_read_b64_tr_b16 a[54:55], v229 offset:51200
    v_mfma_f32_16x16x32_bf16 v[84:87], a[20:23], v[16:19], v[84:87]
    ds_read_b64_tr_b16 a[56:57], v230 offset:49152
    buffer_load_dwordx4 v236, s[36:39], s64 offen offset:2048 lds
    v_mfma_f32_16x16x32_bf16 v[116:119], a[20:23], v[20:23], v[116:119]
    ds_read_b64_tr_b16 a[58:59], v230 offset:51200
    v_mfma_f32_16x16x32_bf16 v[148:151], a[20:23], v[24:27], v[148:151]
    ds_read_b64_tr_b16 a[60:61], v231 offset:49152
    v_mfma_f32_16x16x32_bf16 v[88:91], a[24:27], v[16:19], v[88:91]
    ds_read_b64_tr_b16 a[62:63], v231 offset:51200
    v_mfma_f32_16x16x32_bf16 v[120:123], a[24:27], v[20:23], v[120:123]
    v_mfma_f32_16x16x32_bf16 v[152:155], a[24:27], v[24:27], v[152:155]
    v_mfma_f32_16x16x32_bf16 v[92:95], a[28:31], v[16:19], v[92:95]
    buffer_load_dwordx4 v237, s[36:39], s64 offen offset:3072 lds
    v_mfma_f32_16x16x32_bf16 v[124:127], a[28:31], v[20:23], v[124:127]
    v_mfma_f32_16x16x32_bf16 v[156:159], a[28:31], v[24:27], v[156:159]
    s_waitcnt vmcnt(8) lgkmcnt(0)
    s_barrier
    v_mfma_f32_16x16x32_bf16 v[64:67], a[32:35], v[28:31], v[64:67]
    ds_read_b128 v[16:19], v232 offset:0
    v_mfma_f32_16x16x32_bf16 v[96:99], a[32:35], v[32:35], v[96:99]
    ds_read_b128 v[20:23], v232 offset:2048
    v_mfma_f32_16x16x32_bf16 v[128:131], a[32:35], v[36:39], v[128:131]
    ds_read_b128 v[24:27], v232 offset:4096
    v_mfma_f32_16x16x32_bf16 v[68:71], a[36:39], v[28:31], v[68:71]
    ds_read_b64_tr_b16 a[0:1], v224 offset:0
    s_add_u32 m0, s63, 12288
    s_lshl_b32 s65, s75, 7
    buffer_load_dwordx4 v238, s[32:35], s65 offen offset:0 lds
    v_mfma_f32_16x16x32_bf16 v[100:103], a[36:39], v[32:35], v[100:103]
    ds_read_b64_tr_b16 a[2:3], v224 offset:2048
    v_mfma_f32_16x16x32_bf16 v[132:135], a[36:39], v[36:39], v[132:135]
    ds_read_b64_tr_b16 a[4:5], v225 offset:0
    v_mfma_f32_16x16x32_bf16 v[72:75], a[40:43], v[28:31], v[72:75]
    ds_read_b64_tr_b16 a[6:7], v225 offset:2048
    v_mfma_f32_16x16x32_bf16 v[104:107], a[40:43], v[32:35], v[104:107]
    ds_read_b64_tr_b16 a[8:9], v226 offset:0
    buffer_load_dwordx4 v239, s[32:35], s65 offen offset:1024 lds
    v_mfma_f32_16x16x32_bf16 v[136:139], a[40:43], v[36:39], v[136:139]
    ds_read_b64_tr_b16 a[10:11], v226 offset:2048
    v_mfma_f32_16x16x32_bf16 v[76:79], a[44:47], v[28:31], v[76:79]
    ds_read_b64_tr_b16 a[12:13], v227 offset:0
    v_mfma_f32_16x16x32_bf16 v[108:111], a[44:47], v[32:35], v[108:111]
    ds_read_b64_tr_b16 a[14:15], v227 offset:2048
    v_mfma_f32_16x16x32_bf16 v[140:143], a[44:47], v[36:39], v[140:143]
    ds_read_b64_tr_b16 a[16:17], v228 offset:0
    buffer_load_dwordx4 v240, s[32:35], s65 offen offset:2048 lds
    v_mfma_f32_16x16x32_bf16 v[80:83], a[48:51], v[28:31], v[80:83]
    ds_read_b64_tr_b16 a[18:19], v228 offset:2048
    v_mfma_f32_16x16x32_bf16 v[112:115], a[48:51], v[32:35], v[112:115]
    ds_read_b64_tr_b16 a[20:21], v229 offset:0
    v_mfma_f32_16x16x32_bf16 v[144:147], a[48:51], v[36:39], v[144:147]
    ds_read_b64_tr_b16 a[22:23], v229 offset:2048
    v_mfma_f32_16x16x32_bf16 v[84:87], a[52:55], v[28:31], v[84:87]
    ds_read_b64_tr_b16 a[24:25], v230 offset:0
    s_add_u32 m0, s62, 49152
    s_lshl_b32 s64, s75, 19
    s_add_u32 s64, s64, 262144
    buffer_load_dwordx4 v234, s[36:39], s64 offen offset:0 lds
    v_mfma_f32_16x16x32_bf16 v[116:119], a[52:55], v[32:35], v[116:119]
    ds_read_b64_tr_b16 a[26:27], v230 offset:2048
    v_mfma_f32_16x16x32_bf16 v[148:151], a[52:55], v[36:39], v[148:151]
    ds_read_b64_tr_b16 a[28:29], v231 offset:0
    v_mfma_f32_16x16x32_bf16 v[88:91], a[56:59], v[28:31], v[88:91]
    ds_read_b64_tr_b16 a[30:31], v231 offset:2048
    v_mfma_f32_16x16x32_bf16 v[120:123], a[56:59], v[32:35], v[120:123]
    buffer_load_dwordx4 v235, s[36:39], s64 offen offset:1024 lds
    v_mfma_f32_16x16x32_bf16 v[152:155], a[56:59], v[36:39], v[152:155]
    v_mfma_f32_16x16x32_bf16 v[92:95], a[60:63], v[28:31], v[92:95]
    buffer_load_dwordx4 v236, s[36:39], s64 offen offset:2048 lds
    v_mfma_f32_16x16x32_bf16 v[124:127], a[60:63], v[32:35], v[124:127]
    v_mfma_f32_16x16x32_bf16 v[156:159], a[60:63], v[36:39], v[156:159]
    buffer_load_dwordx4 v237, s[36:39], s64 offen offset:3072 lds
    s_waitcnt vmcnt(11) lgkmcnt(0)
    s_barrier
    v_mfma_f32_16x16x32_bf16 v[64:67], a[0:3], v[16:19], v[64:67]
    ds_read_b128 v[28:31], v233 offset:0
    v_mfma_f32_16x16x32_bf16 v[96:99], a[0:3], v[20:23], v[96:99]
    ds_read_b128 v[32:35], v233 offset:2048
    v_mfma_f32_16x16x32_bf16 v[128:131], a[0:3], v[24:27], v[128:131]
    ds_read_b128 v[36:39], v233 offset:4096
    v_mfma_f32_16x16x32_bf16 v[68:71], a[4:7], v[16:19], v[68:71]
    ds_read_b64_tr_b16 a[32:33], v224 offset:16384
    s_add_u32 m0, s62, 0
    s_lshl_b32 s64, s76, 19
    buffer_load_dwordx4 v234, s[36:39], s64 offen offset:0 lds
    v_mfma_f32_16x16x32_bf16 v[100:103], a[4:7], v[20:23], v[100:103]
    ds_read_b64_tr_b16 a[34:35], v224 offset:18432
    v_mfma_f32_16x16x32_bf16 v[132:135], a[4:7], v[24:27], v[132:135]
    ds_read_b64_tr_b16 a[36:37], v225 offset:16384
    v_mfma_f32_16x16x32_bf16 v[72:75], a[8:11], v[16:19], v[72:75]
    ds_read_b64_tr_b16 a[38:39], v225 offset:18432
    v_mfma_f32_16x16x32_bf16 v[104:107], a[8:11], v[20:23], v[104:107]
    ds_read_b64_tr_b16 a[40:41], v226 offset:16384
    v_mfma_f32_16x16x32_bf16 v[136:139], a[8:11], v[24:27], v[136:139]
    ds_read_b64_tr_b16 a[42:43], v226 offset:18432
    v_mfma_f32_16x16x32_bf16 v[76:79], a[12:15], v[16:19], v[76:79]
    ds_read_b64_tr_b16 a[44:45], v227 offset:16384
    buffer_load_dwordx4 v235, s[36:39], s64 offen offset:1024 lds
    v_mfma_f32_16x16x32_bf16 v[108:111], a[12:15], v[20:23], v[108:111]
    ds_read_b64_tr_b16 a[46:47], v227 offset:18432
    v_mfma_f32_16x16x32_bf16 v[140:143], a[12:15], v[24:27], v[140:143]
    ds_read_b64_tr_b16 a[48:49], v228 offset:16384
    v_mfma_f32_16x16x32_bf16 v[80:83], a[16:19], v[16:19], v[80:83]
    ds_read_b64_tr_b16 a[50:51], v228 offset:18432
    v_mfma_f32_16x16x32_bf16 v[112:115], a[16:19], v[20:23], v[112:115]
    ds_read_b64_tr_b16 a[52:53], v229 offset:16384
    v_mfma_f32_16x16x32_bf16 v[144:147], a[16:19], v[24:27], v[144:147]
    ds_read_b64_tr_b16 a[54:55], v229 offset:18432
    v_mfma_f32_16x16x32_bf16 v[84:87], a[20:23], v[16:19], v[84:87]
    ds_read_b64_tr_b16 a[56:57], v230 offset:16384
    buffer_load_dwordx4 v236, s[36:39], s64 offen offset:2048 lds
    v_mfma_f32_16x16x32_bf16 v[116:119], a[20:23], v[20:23], v[116:119]
    ds_read_b64_tr_b16 a[58:59], v230 offset:18432
    v_mfma_f32_16x16x32_bf16 v[148:151], a[20:23], v[24:27], v[148:151]
    ds_read_b64_tr_b16 a[60:61], v231 offset:16384
    v_mfma_f32_16x16x32_bf16 v[88:91], a[24:27], v[16:19], v[88:91]
    ds_read_b64_tr_b16 a[62:63], v231 offset:18432
    v_mfma_f32_16x16x32_bf16 v[120:123], a[24:27], v[20:23], v[120:123]
    v_mfma_f32_16x16x32_bf16 v[152:155], a[24:27], v[24:27], v[152:155]
    v_mfma_f32_16x16x32_bf16 v[92:95], a[28:31], v[16:19], v[92:95]
    buffer_load_dwordx4 v237, s[36:39], s64 offen offset:3072 lds
    v_mfma_f32_16x16x32_bf16 v[124:127], a[28:31], v[20:23], v[124:127]
    v_mfma_f32_16x16x32_bf16 v[156:159], a[28:31], v[24:27], v[156:159]
    s_waitcnt vmcnt(8) lgkmcnt(0)
    s_barrier
    v_mfma_f32_16x16x32_bf16 v[64:67], a[32:35], v[28:31], v[64:67]
    ds_read_b128 v[16:19], v232 offset:12288
    v_mfma_f32_16x16x32_bf16 v[96:99], a[32:35], v[32:35], v[96:99]
    ds_read_b128 v[20:23], v232 offset:14336
    v_mfma_f32_16x16x32_bf16 v[128:131], a[32:35], v[36:39], v[128:131]
    ds_read_b128 v[24:27], v232 offset:16384
    v_mfma_f32_16x16x32_bf16 v[68:71], a[36:39], v[28:31], v[68:71]
    ds_read_b64_tr_b16 a[0:1], v224 offset:32768
    s_add_u32 m0, s63, 0
    s_lshl_b32 s65, s76, 7
    buffer_load_dwordx4 v238, s[32:35], s65 offen offset:0 lds
    v_mfma_f32_16x16x32_bf16 v[100:103], a[36:39], v[32:35], v[100:103]
    ds_read_b64_tr_b16 a[2:3], v224 offset:34816
    v_mfma_f32_16x16x32_bf16 v[132:135], a[36:39], v[36:39], v[132:135]
    ds_read_b64_tr_b16 a[4:5], v225 offset:32768
    v_mfma_f32_16x16x32_bf16 v[72:75], a[40:43], v[28:31], v[72:75]
    ds_read_b64_tr_b16 a[6:7], v225 offset:34816
    v_mfma_f32_16x16x32_bf16 v[104:107], a[40:43], v[32:35], v[104:107]
    ds_read_b64_tr_b16 a[8:9], v226 offset:32768
    buffer_load_dwordx4 v239, s[32:35], s65 offen offset:1024 lds
    v_mfma_f32_16x16x32_bf16 v[136:139], a[40:43], v[36:39], v[136:139]
    ds_read_b64_tr_b16 a[10:11], v226 offset:34816
    v_mfma_f32_16x16x32_bf16 v[76:79], a[44:47], v[28:31], v[76:79]
    ds_read_b64_tr_b16 a[12:13], v227 offset:32768
    v_mfma_f32_16x16x32_bf16 v[108:111], a[44:47], v[32:35], v[108:111]
    ds_read_b64_tr_b16 a[14:15], v227 offset:34816
    v_mfma_f32_16x16x32_bf16 v[140:143], a[44:47], v[36:39], v[140:143]
    ds_read_b64_tr_b16 a[16:17], v228 offset:32768
    buffer_load_dwordx4 v240, s[32:35], s65 offen offset:2048 lds
    v_mfma_f32_16x16x32_bf16 v[80:83], a[48:51], v[28:31], v[80:83]
    ds_read_b64_tr_b16 a[18:19], v228 offset:34816
    v_mfma_f32_16x16x32_bf16 v[112:115], a[48:51], v[32:35], v[112:115]
    ds_read_b64_tr_b16 a[20:21], v229 offset:32768
    v_mfma_f32_16x16x32_bf16 v[144:147], a[48:51], v[36:39], v[144:147]
    ds_read_b64_tr_b16 a[22:23], v229 offset:34816
    v_mfma_f32_16x16x32_bf16 v[84:87], a[52:55], v[28:31], v[84:87]
    ds_read_b64_tr_b16 a[24:25], v230 offset:32768
    s_add_u32 m0, s62, 16384
    s_lshl_b32 s64, s76, 19
    s_add_u32 s64, s64, 262144
    buffer_load_dwordx4 v234, s[36:39], s64 offen offset:0 lds
    v_mfma_f32_16x16x32_bf16 v[116:119], a[52:55], v[32:35], v[116:119]
    ds_read_b64_tr_b16 a[26:27], v230 offset:34816
    v_mfma_f32_16x16x32_bf16 v[148:151], a[52:55], v[36:39], v[148:151]
    ds_read_b64_tr_b16 a[28:29], v231 offset:32768
    v_mfma_f32_16x16x32_bf16 v[88:91], a[56:59], v[28:31], v[88:91]
    ds_read_b64_tr_b16 a[30:31], v231 offset:34816
    v_mfma_f32_16x16x32_bf16 v[120:123], a[56:59], v[32:35], v[120:123]
    buffer_load_dwordx4 v235, s[36:39], s64 offen offset:1024 lds
    v_mfma_f32_16x16x32_bf16 v[152:155], a[56:59], v[36:39], v[152:155]
    v_mfma_f32_16x16x32_bf16 v[92:95], a[60:63], v[28:31], v[92:95]
    buffer_load_dwordx4 v236, s[36:39], s64 offen offset:2048 lds
    v_mfma_f32_16x16x32_bf16 v[124:127], a[60:63], v[32:35], v[124:127]
    v_mfma_f32_16x16x32_bf16 v[156:159], a[60:63], v[36:39], v[156:159]
    buffer_load_dwordx4 v237, s[36:39], s64 offen offset:3072 lds
    s_waitcnt vmcnt(11) lgkmcnt(0)
    s_barrier
    v_mfma_f32_16x16x32_bf16 v[64:67], a[0:3], v[16:19], v[64:67]
    ds_read_b128 v[28:31], v233 offset:12288
    v_mfma_f32_16x16x32_bf16 v[96:99], a[0:3], v[20:23], v[96:99]
    ds_read_b128 v[32:35], v233 offset:14336
    v_mfma_f32_16x16x32_bf16 v[128:131], a[0:3], v[24:27], v[128:131]
    ds_read_b128 v[36:39], v233 offset:16384
    v_mfma_f32_16x16x32_bf16 v[68:71], a[4:7], v[16:19], v[68:71]
    ds_read_b64_tr_b16 a[32:33], v224 offset:49152
    s_add_u32 m0, s62, 32768
    s_lshl_b32 s64, s77, 19
    buffer_load_dwordx4 v234, s[36:39], s64 offen offset:0 lds
    v_mfma_f32_16x16x32_bf16 v[100:103], a[4:7], v[20:23], v[100:103]
    ds_read_b64_tr_b16 a[34:35], v224 offset:51200
    v_mfma_f32_16x16x32_bf16 v[132:135], a[4:7], v[24:27], v[132:135]
    ds_read_b64_tr_b16 a[36:37], v225 offset:49152
    v_mfma_f32_16x16x32_bf16 v[72:75], a[8:11], v[16:19], v[72:75]
    ds_read_b64_tr_b16 a[38:39], v225 offset:51200
    v_mfma_f32_16x16x32_bf16 v[104:107], a[8:11], v[20:23], v[104:107]
    ds_read_b64_tr_b16 a[40:41], v226 offset:49152
    v_mfma_f32_16x16x32_bf16 v[136:139], a[8:11], v[24:27], v[136:139]
    ds_read_b64_tr_b16 a[42:43], v226 offset:51200
    v_mfma_f32_16x16x32_bf16 v[76:79], a[12:15], v[16:19], v[76:79]
    ds_read_b64_tr_b16 a[44:45], v227 offset:49152
    buffer_load_dwordx4 v235, s[36:39], s64 offen offset:1024 lds
    v_mfma_f32_16x16x32_bf16 v[108:111], a[12:15], v[20:23], v[108:111]
    ds_read_b64_tr_b16 a[46:47], v227 offset:51200
    v_mfma_f32_16x16x32_bf16 v[140:143], a[12:15], v[24:27], v[140:143]
    ds_read_b64_tr_b16 a[48:49], v228 offset:49152
    v_mfma_f32_16x16x32_bf16 v[80:83], a[16:19], v[16:19], v[80:83]
    ds_read_b64_tr_b16 a[50:51], v228 offset:51200
    v_mfma_f32_16x16x32_bf16 v[112:115], a[16:19], v[20:23], v[112:115]
    ds_read_b64_tr_b16 a[52:53], v229 offset:49152
    v_mfma_f32_16x16x32_bf16 v[144:147], a[16:19], v[24:27], v[144:147]
    ds_read_b64_tr_b16 a[54:55], v229 offset:51200
    v_mfma_f32_16x16x32_bf16 v[84:87], a[20:23], v[16:19], v[84:87]
    ds_read_b64_tr_b16 a[56:57], v230 offset:49152
    buffer_load_dwordx4 v236, s[36:39], s64 offen offset:2048 lds
    v_mfma_f32_16x16x32_bf16 v[116:119], a[20:23], v[20:23], v[116:119]
    ds_read_b64_tr_b16 a[58:59], v230 offset:51200
    v_mfma_f32_16x16x32_bf16 v[148:151], a[20:23], v[24:27], v[148:151]
    ds_read_b64_tr_b16 a[60:61], v231 offset:49152
    v_mfma_f32_16x16x32_bf16 v[88:91], a[24:27], v[16:19], v[88:91]
    ds_read_b64_tr_b16 a[62:63], v231 offset:51200
    v_mfma_f32_16x16x32_bf16 v[120:123], a[24:27], v[20:23], v[120:123]
    v_mfma_f32_16x16x32_bf16 v[152:155], a[24:27], v[24:27], v[152:155]
    v_mfma_f32_16x16x32_bf16 v[92:95], a[28:31], v[16:19], v[92:95]
    buffer_load_dwordx4 v237, s[36:39], s64 offen offset:3072 lds
    v_mfma_f32_16x16x32_bf16 v[124:127], a[28:31], v[20:23], v[124:127]
    v_mfma_f32_16x16x32_bf16 v[156:159], a[28:31], v[24:27], v[156:159]
    s_waitcnt vmcnt(8) lgkmcnt(0)
    s_barrier
    v_mfma_f32_16x16x32_bf16 v[64:67], a[32:35], v[28:31], v[64:67]
    ds_read_b128 v[16:19], v232 offset:0
    v_mfma_f32_16x16x32_bf16 v[96:99], a[32:35], v[32:35], v[96:99]
    ds_read_b128 v[20:23], v232 offset:2048
    v_mfma_f32_16x16x32_bf16 v[128:131], a[32:35], v[36:39], v[128:131]
    ds_read_b128 v[24:27], v232 offset:4096
    v_mfma_f32_16x16x32_bf16 v[68:71], a[36:39], v[28:31], v[68:71]
    ds_read_b64_tr_b16 a[0:1], v224 offset:0
    s_add_u32 m0, s63, 12288
    s_lshl_b32 s65, s77, 7
    buffer_load_dwordx4 v238, s[32:35], s65 offen offset:0 lds
    v_mfma_f32_16x16x32_bf16 v[100:103], a[36:39], v[32:35], v[100:103]
    ds_read_b64_tr_b16 a[2:3], v224 offset:2048
    v_mfma_f32_16x16x32_bf16 v[132:135], a[36:39], v[36:39], v[132:135]
    ds_read_b64_tr_b16 a[4:5], v225 offset:0
    v_mfma_f32_16x16x32_bf16 v[72:75], a[40:43], v[28:31], v[72:75]
    ds_read_b64_tr_b16 a[6:7], v225 offset:2048
    v_mfma_f32_16x16x32_bf16 v[104:107], a[40:43], v[32:35], v[104:107]
    ds_read_b64_tr_b16 a[8:9], v226 offset:0
    buffer_load_dwordx4 v239, s[32:35], s65 offen offset:1024 lds
    v_mfma_f32_16x16x32_bf16 v[136:139], a[40:43], v[36:39], v[136:139]
    ds_read_b64_tr_b16 a[10:11], v226 offset:2048
    v_mfma_f32_16x16x32_bf16 v[76:79], a[44:47], v[28:31], v[76:79]
    ds_read_b64_tr_b16 a[12:13], v227 offset:0
    v_mfma_f32_16x16x32_bf16 v[108:111], a[44:47], v[32:35], v[108:111]
    ds_read_b64_tr_b16 a[14:15], v227 offset:2048
    v_mfma_f32_16x16x32_bf16 v[140:143], a[44:47], v[36:39], v[140:143]
    ds_read_b64_tr_b16 a[16:17], v228 offset:0
    buffer_load_dwordx4 v240, s[32:35], s65 offen offset:2048 lds
    v_mfma_f32_16x16x32_bf16 v[80:83], a[48:51], v[28:31], v[80:83]
    ds_read_b64_tr_b16 a[18:19], v228 offset:2048
    v_mfma_f32_16x16x32_bf16 v[112:115], a[48:51], v[32:35], v[112:115]
    ds_read_b64_tr_b16 a[20:21], v229 offset:0
    v_mfma_f32_16x16x32_bf16 v[144:147], a[48:51], v[36:39], v[144:147]
    ds_read_b64_tr_b16 a[22:23], v229 offset:2048
    v_mfma_f32_16x16x32_bf16 v[84:87], a[52:55], v[28:31], v[84:87]
    ds_read_b64_tr_b16 a[24:25], v230 offset:0
    s_add_u32 m0, s62, 49152
    s_lshl_b32 s64, s77, 19
    s_add_u32 s64, s64, 262144
    buffer_load_dwordx4 v234, s[36:39], s64 offen offset:0 lds
    v_mfma_f32_16x16x32_bf16 v[116:119], a[52:55], v[32:35], v[116:119]
    ds_read_b64_tr_b16 a[26:27], v230 offset:2048
    v_mfma_f32_16x16x32_bf16 v[148:151], a[52:55], v[36:39], v[148:151]
    ds_read_b64_tr_b16 a[28:29], v231 offset:0
    v_mfma_f32_16x16x32_bf16 v[88:91], a[56:59], v[28:31], v[88:91]
    ds_read_b64_tr_b16 a[30:31], v231 offset:2048
    v_mfma_f32_16x16x32_bf16 v[120:123], a[56:59], v[32:35], v[120:123]
    buffer_load_dwordx4 v235, s[36:39], s64 offen offset:1024 lds
    v_mfma_f32_16x16x32_bf16 v[152:155], a[56:59], v[36:39], v[152:155]
    v_mfma_f32_16x16x32_bf16 v[92:95], a[60:63], v[28:31], v[92:95]
    buffer_load_dwordx4 v236, s[36:39], s64 offen offset:2048 lds
    v_mfma_f32_16x16x32_bf16 v[124:127], a[60:63], v[32:35], v[124:127]
    v_mfma_f32_16x16x32_bf16 v[156:159], a[60:63], v[36:39], v[156:159]
    buffer_load_dwordx4 v237, s[36:39], s64 offen offset:3072 lds
    s_waitcnt vmcnt(11) lgkmcnt(0)
    s_barrier
    v_mfma_f32_16x16x32_bf16 v[64:67], a[0:3], v[16:19], v[64:67]
    ds_read_b128 v[28:31], v233 offset:0
    v_mfma_f32_16x16x32_bf16 v[96:99], a[0:3], v[20:23], v[96:99]
    ds_read_b128 v[32:35], v233 offset:2048
    v_mfma_f32_16x16x32_bf16 v[128:131], a[0:3], v[24:27], v[128:131]
    ds_read_b128 v[36:39], v233 offset:4096
    v_mfma_f32_16x16x32_bf16 v[68:71], a[4:7], v[16:19], v[68:71]
    ds_read_b64_tr_b16 a[32:33], v224 offset:16384
    s_add_u32 m0, s62, 0
    s_lshl_b32 s64, s78, 19
    buffer_load_dwordx4 v234, s[36:39], s64 offen offset:0 lds
    v_mfma_f32_16x16x32_bf16 v[100:103], a[4:7], v[20:23], v[100:103]
    ds_read_b64_tr_b16 a[34:35], v224 offset:18432
    v_mfma_f32_16x16x32_bf16 v[132:135], a[4:7], v[24:27], v[132:135]
    ds_read_b64_tr_b16 a[36:37], v225 offset:16384
    v_mfma_f32_16x16x32_bf16 v[72:75], a[8:11], v[16:19], v[72:75]
    ds_read_b64_tr_b16 a[38:39], v225 offset:18432
    v_mfma_f32_16x16x32_bf16 v[104:107], a[8:11], v[20:23], v[104:107]
    ds_read_b64_tr_b16 a[40:41], v226 offset:16384
    v_mfma_f32_16x16x32_bf16 v[136:139], a[8:11], v[24:27], v[136:139]
    ds_read_b64_tr_b16 a[42:43], v226 offset:18432
    v_mfma_f32_16x16x32_bf16 v[76:79], a[12:15], v[16:19], v[76:79]
    ds_read_b64_tr_b16 a[44:45], v227 offset:16384
    buffer_load_dwordx4 v235, s[36:39], s64 offen offset:1024 lds
    v_mfma_f32_16x16x32_bf16 v[108:111], a[12:15], v[20:23], v[108:111]
    ds_read_b64_tr_b16 a[46:47], v227 offset:18432
    v_mfma_f32_16x16x32_bf16 v[140:143], a[12:15], v[24:27], v[140:143]
    ds_read_b64_tr_b16 a[48:49], v228 offset:16384
    v_mfma_f32_16x16x32_bf16 v[80:83], a[16:19], v[16:19], v[80:83]
    ds_read_b64_tr_b16 a[50:51], v228 offset:18432
    v_mfma_f32_16x16x32_bf16 v[112:115], a[16:19], v[20:23], v[112:115]
    ds_read_b64_tr_b16 a[52:53], v229 offset:16384
    v_mfma_f32_16x16x32_bf16 v[144:147], a[16:19], v[24:27], v[144:147]
    ds_read_b64_tr_b16 a[54:55], v229 offset:18432
    v_mfma_f32_16x16x32_bf16 v[84:87], a[20:23], v[16:19], v[84:87]
    ds_read_b64_tr_b16 a[56:57], v230 offset:16384
    buffer_load_dwordx4 v236, s[36:39], s64 offen offset:2048 lds
    v_mfma_f32_16x16x32_bf16 v[116:119], a[20:23], v[20:23], v[116:119]
    ds_read_b64_tr_b16 a[58:59], v230 offset:18432
    v_mfma_f32_16x16x32_bf16 v[148:151], a[20:23], v[24:27], v[148:151]
    ds_read_b64_tr_b16 a[60:61], v231 offset:16384
    v_mfma_f32_16x16x32_bf16 v[88:91], a[24:27], v[16:19], v[88:91]
    ds_read_b64_tr_b16 a[62:63], v231 offset:18432
    v_mfma_f32_16x16x32_bf16 v[120:123], a[24:27], v[20:23], v[120:123]
    v_mfma_f32_16x16x32_bf16 v[152:155], a[24:27], v[24:27], v[152:155]
    v_mfma_f32_16x16x32_bf16 v[92:95], a[28:31], v[16:19], v[92:95]
    buffer_load_dwordx4 v237, s[36:39], s64 offen offset:3072 lds
    v_mfma_f32_16x16x32_bf16 v[124:127], a[28:31], v[20:23], v[124:127]
    v_mfma_f32_16x16x32_bf16 v[156:159], a[28:31], v[24:27], v[156:159]
    s_waitcnt vmcnt(8) lgkmcnt(0)
    s_barrier
    v_mfma_f32_16x16x32_bf16 v[64:67], a[32:35], v[28:31], v[64:67]
    ds_read_b128 v[16:19], v232 offset:12288
    v_mfma_f32_16x16x32_bf16 v[96:99], a[32:35], v[32:35], v[96:99]
    ds_read_b128 v[20:23], v232 offset:14336
    v_mfma_f32_16x16x32_bf16 v[128:131], a[32:35], v[36:39], v[128:131]
    ds_read_b128 v[24:27], v232 offset:16384
    v_mfma_f32_16x16x32_bf16 v[68:71], a[36:39], v[28:31], v[68:71]
    ds_read_b64_tr_b16 a[0:1], v224 offset:32768
    s_add_u32 m0, s63, 0
    s_lshl_b32 s65, s78, 7
    buffer_load_dwordx4 v238, s[32:35], s65 offen offset:0 lds
    v_mfma_f32_16x16x32_bf16 v[100:103], a[36:39], v[32:35], v[100:103]
    ds_read_b64_tr_b16 a[2:3], v224 offset:34816
    v_mfma_f32_16x16x32_bf16 v[132:135], a[36:39], v[36:39], v[132:135]
    ds_read_b64_tr_b16 a[4:5], v225 offset:32768
    v_mfma_f32_16x16x32_bf16 v[72:75], a[40:43], v[28:31], v[72:75]
    ds_read_b64_tr_b16 a[6:7], v225 offset:34816
    v_mfma_f32_16x16x32_bf16 v[104:107], a[40:43], v[32:35], v[104:107]
    ds_read_b64_tr_b16 a[8:9], v226 offset:32768
    buffer_load_dwordx4 v239, s[32:35], s65 offen offset:1024 lds
    v_mfma_f32_16x16x32_bf16 v[136:139], a[40:43], v[36:39], v[136:139]
    ds_read_b64_tr_b16 a[10:11], v226 offset:34816
    v_mfma_f32_16x16x32_bf16 v[76:79], a[44:47], v[28:31], v[76:79]
    ds_read_b64_tr_b16 a[12:13], v227 offset:32768
    v_mfma_f32_16x16x32_bf16 v[108:111], a[44:47], v[32:35], v[108:111]
    ds_read_b64_tr_b16 a[14:15], v227 offset:34816
    v_mfma_f32_16x16x32_bf16 v[140:143], a[44:47], v[36:39], v[140:143]
    ds_read_b64_tr_b16 a[16:17], v228 offset:32768
    buffer_load_dwordx4 v240, s[32:35], s65 offen offset:2048 lds
    v_mfma_f32_16x16x32_bf16 v[80:83], a[48:51], v[28:31], v[80:83]
    ds_read_b64_tr_b16 a[18:19], v228 offset:34816
    v_mfma_f32_16x16x32_bf16 v[112:115], a[48:51], v[32:35], v[112:115]
    ds_read_b64_tr_b16 a[20:21], v229 offset:32768
    v_mfma_f32_16x16x32_bf16 v[144:147], a[48:51], v[36:39], v[144:147]
    ds_read_b64_tr_b16 a[22:23], v229 offset:34816
    v_mfma_f32_16x16x32_bf16 v[84:87], a[52:55], v[28:31], v[84:87]
    ds_read_b64_tr_b16 a[24:25], v230 offset:32768
    s_add_u32 m0, s62, 16384
    s_lshl_b32 s64, s78, 19
    s_add_u32 s64, s64, 262144
    buffer_load_dwordx4 v234, s[36:39], s64 offen offset:0 lds
    v_mfma_f32_16x16x32_bf16 v[116:119], a[52:55], v[32:35], v[116:119]
    ds_read_b64_tr_b16 a[26:27], v230 offset:34816
    v_mfma_f32_16x16x32_bf16 v[148:151], a[52:55], v[36:39], v[148:151]
    ds_read_b64_tr_b16 a[28:29], v231 offset:32768
    v_mfma_f32_16x16x32_bf16 v[88:91], a[56:59], v[28:31], v[88:91]
    ds_read_b64_tr_b16 a[30:31], v231 offset:34816
    v_mfma_f32_16x16x32_bf16 v[120:123], a[56:59], v[32:35], v[120:123]
    buffer_load_dwordx4 v235, s[36:39], s64 offen offset:1024 lds
    v_mfma_f32_16x16x32_bf16 v[152:155], a[56:59], v[36:39], v[152:155]
    v_mfma_f32_16x16x32_bf16 v[92:95], a[60:63], v[28:31], v[92:95]
    buffer_load_dwordx4 v236, s[36:39], s64 offen offset:2048 lds
    v_mfma_f32_16x16x32_bf16 v[124:127], a[60:63], v[32:35], v[124:127]
    v_mfma_f32_16x16x32_bf16 v[156:159], a[60:63], v[36:39], v[156:159]
    buffer_load_dwordx4 v237, s[36:39], s64 offen offset:3072 lds
    s_waitcnt vmcnt(11) lgkmcnt(0)
    s_barrier
    v_mfma_f32_16x16x32_bf16 v[64:67], a[0:3], v[16:19], v[64:67]
    ds_read_b128 v[28:31], v233 offset:12288
    v_mfma_f32_16x16x32_bf16 v[96:99], a[0:3], v[20:23], v[96:99]
    ds_read_b128 v[32:35], v233 offset:14336
    v_mfma_f32_16x16x32_bf16 v[128:131], a[0:3], v[24:27], v[128:131]
    ds_read_b128 v[36:39], v233 offset:16384
    v_mfma_f32_16x16x32_bf16 v[68:71], a[4:7], v[16:19], v[68:71]
    ds_read_b64_tr_b16 a[32:33], v224 offset:49152
    s_add_u32 m0, s59, 0
    s_mov_b32 s66, 0
    buffer_load_dwordx4 v220, s[40:43], s66 offen offset:0 nt lds
    v_mfma_f32_16x16x32_bf16 v[100:103], a[4:7], v[20:23], v[100:103]
    ds_read_b64_tr_b16 a[34:35], v224 offset:51200
    v_mfma_f32_16x16x32_bf16 v[132:135], a[4:7], v[24:27], v[132:135]
    ds_read_b64_tr_b16 a[36:37], v225 offset:49152
    v_mfma_f32_16x16x32_bf16 v[72:75], a[8:11], v[16:19], v[72:75]
    ds_read_b64_tr_b16 a[38:39], v225 offset:51200
    v_mfma_f32_16x16x32_bf16 v[104:107], a[8:11], v[20:23], v[104:107]
    ds_read_b64_tr_b16 a[40:41], v226 offset:49152
    v_mfma_f32_16x16x32_bf16 v[136:139], a[8:11], v[24:27], v[136:139]
    ds_read_b64_tr_b16 a[42:43], v226 offset:51200
    v_mfma_f32_16x16x32_bf16 v[76:79], a[12:15], v[16:19], v[76:79]
    ds_read_b64_tr_b16 a[44:45], v227 offset:49152
    s_add_u32 m0, s59, 0
    s_mov_b32 s66, 0
    buffer_load_dwordx4 v221, s[40:43], s66 offen offset:1024 nt lds
    v_mfma_f32_16x16x32_bf16 v[108:111], a[12:15], v[20:23], v[108:111]
    ds_read_b64_tr_b16 a[46:47], v227 offset:51200
    v_mfma_f32_16x16x32_bf16 v[140:143], a[12:15], v[24:27], v[140:143]
    ds_read_b64_tr_b16 a[48:49], v228 offset:49152
    v_mfma_f32_16x16x32_bf16 v[80:83], a[16:19], v[16:19], v[80:83]
    ds_read_b64_tr_b16 a[50:51], v228 offset:51200
    v_mfma_f32_16x16x32_bf16 v[112:115], a[16:19], v[20:23], v[112:115]
    ds_read_b64_tr_b16 a[52:53], v229 offset:49152
    v_mfma_f32_16x16x32_bf16 v[144:147], a[16:19], v[24:27], v[144:147]
    ds_read_b64_tr_b16 a[54:55], v229 offset:51200
    v_mfma_f32_16x16x32_bf16 v[84:87], a[20:23], v[16:19], v[84:87]
    ds_read_b64_tr_b16 a[56:57], v230 offset:49152
    s_add_u32 m0, s59, 32768
    s_mov_b32 s66, 0
    buffer_load_dwordx4 v222, s[44:47], s66 offen offset:0 nt lds
    v_mfma_f32_16x16x32_bf16 v[116:119], a[20:23], v[20:23], v[116:119]
    ds_read_b64_tr_b16 a[58:59], v230 offset:51200
    v_mfma_f32_16x16x32_bf16 v[148:151], a[20:23], v[24:27], v[148:151]
    ds_read_b64_tr_b16 a[60:61], v231 offset:49152
    v_mfma_f32_16x16x32_bf16 v[88:91], a[24:27], v[16:19], v[88:91]
    ds_read_b64_tr_b16 a[62:63], v231 offset:51200
    v_mfma_f32_16x16x32_bf16 v[120:123], a[24:27], v[20:23], v[120:123]
    v_mfma_f32_16x16x32_bf16 v[152:155], a[24:27], v[24:27], v[152:155]
    v_mfma_f32_16x16x32_bf16 v[92:95], a[28:31], v[16:19], v[92:95]
    s_add_u32 m0, s59, 32768
    s_mov_b32 s66, 0
    buffer_load_dwordx4 v223, s[44:47], s66 offen offset:1024 nt lds
    v_mfma_f32_16x16x32_bf16 v[124:127], a[28:31], v[20:23], v[124:127]
    v_mfma_f32_16x16x32_bf16 v[156:159], a[28:31], v[24:27], v[156:159]
    s_waitcnt vmcnt(8) lgkmcnt(0)
    s_barrier
    v_mfma_f32_16x16x32_bf16 v[64:67], a[32:35], v[28:31], v[64:67]
    ds_read_b128 v[16:19], v232 offset:0
    v_mfma_f32_16x16x32_bf16 v[96:99], a[32:35], v[32:35], v[96:99]
    ds_read_b128 v[20:23], v232 offset:2048
    v_mfma_f32_16x16x32_bf16 v[128:131], a[32:35], v[36:39], v[128:131]
    ds_read_b128 v[24:27], v232 offset:4096
    v_mfma_f32_16x16x32_bf16 v[68:71], a[36:39], v[28:31], v[68:71]
    ds_read_b64_tr_b16 a[0:1], v224 offset:0
    s_add_u32 m0, s59, 8192
    s_mov_b32 s66, 8192
    buffer_load_dwordx4 v220, s[40:43], s66 offen offset:0 nt lds
    v_mfma_f32_16x16x32_bf16 v[100:103], a[36:39], v[32:35], v[100:103]
    ds_read_b64_tr_b16 a[2:3], v224 offset:2048
    v_mfma_f32_16x16x32_bf16 v[132:135], a[36:39], v[36:39], v[132:135]
    ds_read_b64_tr_b16 a[4:5], v225 offset:0
    v_mfma_f32_16x16x32_bf16 v[72:75], a[40:43], v[28:31], v[72:75]
    ds_read_b64_tr_b16 a[6:7], v225 offset:2048
    v_mfma_f32_16x16x32_bf16 v[104:107], a[40:43], v[32:35], v[104:107]
    ds_read_b64_tr_b16 a[8:9], v226 offset:0
    v_mfma_f32_16x16x32_bf16 v[136:139], a[40:43], v[36:39], v[136:139]
    ds_read_b64_tr_b16 a[10:11], v226 offset:2048
    v_mfma_f32_16x16x32_bf16 v[76:79], a[44:47], v[28:31], v[76:79]
    ds_read_b64_tr_b16 a[12:13], v227 offset:0
    s_add_u32 m0, s59, 8192
    s_mov_b32 s66, 8192
    buffer_load_dwordx4 v221, s[40:43], s66 offen offset:1024 nt lds
    v_mfma_f32_16x16x32_bf16 v[108:111], a[44:47], v[32:35], v[108:111]
    ds_read_b64_tr_b16 a[14:15], v227 offset:2048
    v_mfma_f32_16x16x32_bf16 v[140:143], a[44:47], v[36:39], v[140:143]
    ds_read_b64_tr_b16 a[16:17], v228 offset:0
    v_mfma_f32_16x16x32_bf16 v[80:83], a[48:51], v[28:31], v[80:83]
    ds_read_b64_tr_b16 a[18:19], v228 offset:2048
    v_mfma_f32_16x16x32_bf16 v[112:115], a[48:51], v[32:35], v[112:115]
    ds_read_b64_tr_b16 a[20:21], v229 offset:0
    v_mfma_f32_16x16x32_bf16 v[144:147], a[48:51], v[36:39], v[144:147]
    ds_read_b64_tr_b16 a[22:23], v229 offset:2048
    v_mfma_f32_16x16x32_bf16 v[84:87], a[52:55], v[28:31], v[84:87]
    ds_read_b64_tr_b16 a[24:25], v230 offset:0
    s_add_u32 m0, s59, 40960
    s_mov_b32 s66, 8192
    buffer_load_dwordx4 v222, s[44:47], s66 offen offset:0 nt lds
    v_mfma_f32_16x16x32_bf16 v[116:119], a[52:55], v[32:35], v[116:119]
    ds_read_b64_tr_b16 a[26:27], v230 offset:2048
    v_mfma_f32_16x16x32_bf16 v[148:151], a[52:55], v[36:39], v[148:151]
    ds_read_b64_tr_b16 a[28:29], v231 offset:0
    v_mfma_f32_16x16x32_bf16 v[88:91], a[56:59], v[28:31], v[88:91]
    ds_read_b64_tr_b16 a[30:31], v231 offset:2048
    v_mfma_f32_16x16x32_bf16 v[120:123], a[56:59], v[32:35], v[120:123]
    v_mfma_f32_16x16x32_bf16 v[152:155], a[56:59], v[36:39], v[152:155]
    v_mfma_f32_16x16x32_bf16 v[92:95], a[60:63], v[28:31], v[92:95]
    s_add_u32 m0, s59, 40960
    s_mov_b32 s66, 8192
    buffer_load_dwordx4 v223, s[44:47], s66 offen offset:1024 nt lds
    v_mfma_f32_16x16x32_bf16 v[124:127], a[60:63], v[32:35], v[124:127]
    v_mfma_f32_16x16x32_bf16 v[156:159], a[60:63], v[36:39], v[156:159]
    s_waitcnt vmcnt(8) lgkmcnt(0)
    s_barrier
    v_mfma_f32_16x16x32_bf16 v[64:67], a[0:3], v[16:19], v[64:67]
    ds_read_b128 v[28:31], v233 offset:0
    v_mfma_f32_16x16x32_bf16 v[96:99], a[0:3], v[20:23], v[96:99]
    ds_read_b128 v[32:35], v233 offset:2048
    v_mfma_f32_16x16x32_bf16 v[128:131], a[0:3], v[24:27], v[128:131]
    ds_read_b128 v[36:39], v233 offset:4096
    v_mfma_f32_16x16x32_bf16 v[68:71], a[4:7], v[16:19], v[68:71]
    ds_read_b64_tr_b16 a[32:33], v224 offset:16384
    v_mfma_f32_16x16x32_bf16 v[100:103], a[4:7], v[20:23], v[100:103]
    ds_read_b64_tr_b16 a[34:35], v224 offset:18432
    v_mfma_f32_16x16x32_bf16 v[132:135], a[4:7], v[24:27], v[132:135]
    ds_read_b64_tr_b16 a[36:37], v225 offset:16384
    v_mfma_f32_16x16x32_bf16 v[72:75], a[8:11], v[16:19], v[72:75]
    ds_read_b64_tr_b16 a[38:39], v225 offset:18432
    v_mfma_f32_16x16x32_bf16 v[104:107], a[8:11], v[20:23], v[104:107]
    ds_read_b64_tr_b16 a[40:41], v226 offset:16384
    v_mfma_f32_16x16x32_bf16 v[136:139], a[8:11], v[24:27], v[136:139]
    ds_read_b64_tr_b16 a[42:43], v226 offset:18432
    v_mfma_f32_16x16x32_bf16 v[76:79], a[12:15], v[16:19], v[76:79]
    ds_read_b64_tr_b16 a[44:45], v227 offset:16384
    v_mfma_f32_16x16x32_bf16 v[108:111], a[12:15], v[20:23], v[108:111]
    ds_read_b64_tr_b16 a[46:47], v227 offset:18432
    v_mfma_f32_16x16x32_bf16 v[140:143], a[12:15], v[24:27], v[140:143]
    ds_read_b64_tr_b16 a[48:49], v228 offset:16384
    v_mfma_f32_16x16x32_bf16 v[80:83], a[16:19], v[16:19], v[80:83]
    ds_read_b64_tr_b16 a[50:51], v228 offset:18432
    v_mfma_f32_16x16x32_bf16 v[112:115], a[16:19], v[20:23], v[112:115]
    ds_read_b64_tr_b16 a[52:53], v229 offset:16384
    v_mfma_f32_16x16x32_bf16 v[144:147], a[16:19], v[24:27], v[144:147]
    ds_read_b64_tr_b16 a[54:55], v229 offset:18432
    v_mfma_f32_16x16x32_bf16 v[84:87], a[20:23], v[16:19], v[84:87]
    ds_read_b64_tr_b16 a[56:57], v230 offset:16384
    v_mfma_f32_16x16x32_bf16 v[116:119], a[20:23], v[20:23], v[116:119]
    ds_read_b64_tr_b16 a[58:59], v230 offset:18432
    v_mfma_f32_16x16x32_bf16 v[148:151], a[20:23], v[24:27], v[148:151]
    ds_read_b64_tr_b16 a[60:61], v231 offset:16384
    v_mfma_f32_16x16x32_bf16 v[88:91], a[24:27], v[16:19], v[88:91]
    ds_read_b64_tr_b16 a[62:63], v231 offset:18432
    v_mfma_f32_16x16x32_bf16 v[120:123], a[24:27], v[20:23], v[120:123]
    v_mfma_f32_16x16x32_bf16 v[152:155], a[24:27], v[24:27], v[152:155]
    v_mfma_f32_16x16x32_bf16 v[92:95], a[28:31], v[16:19], v[92:95]
    v_mfma_f32_16x16x32_bf16 v[124:127], a[28:31], v[20:23], v[124:127]
    v_mfma_f32_16x16x32_bf16 v[156:159], a[28:31], v[24:27], v[156:159]
    s_mov_b32 s68, 0x3e0293ee
    s_mov_b32 s69, 0x3e0293ee
    s_waitcnt vmcnt(4) lgkmcnt(0)
    s_barrier
    v_mfma_f32_16x16x32_bf16 v[64:67], a[32:35], v[28:31], v[64:67]
    ds_read_b128 a[0:3], v4 offset:0
    v_mfma_f32_16x16x32_bf16 v[68:71], a[36:39], v[28:31], v[68:71]
    ds_read_b128 a[4:7], v5 offset:0
    s_add_u32 m0, s59, 16384
    s_mov_b32 s66, 16384
    buffer_load_dwordx4 v220, s[40:43], s66 offen offset:0 nt lds
    v_mfma_f32_16x16x32_bf16 v[72:75], a[40:43], v[28:31], v[72:75]
    ds_read_b128 a[8:11], v6 offset:0
    v_mfma_f32_16x16x32_bf16 v[76:79], a[44:47], v[28:31], v[76:79]
    ds_read_b128 a[12:15], v7 offset:0
    v_mfma_f32_16x16x32_bf16 v[80:83], a[48:51], v[28:31], v[80:83]
    ds_read_b128 a[16:19], v4 offset:4096
    v_mfma_f32_16x16x32_bf16 v[84:87], a[52:55], v[28:31], v[84:87]
    ds_read_b128 a[20:23], v5 offset:4096
    s_add_u32 m0, s59, 16384
    s_mov_b32 s66, 16384
    buffer_load_dwordx4 v221, s[40:43], s66 offen offset:1024 nt lds
    v_mfma_f32_16x16x32_bf16 v[88:91], a[56:59], v[28:31], v[88:91]
    ds_read_b128 a[24:27], v6 offset:4096
    v_mfma_f32_16x16x32_bf16 v[92:95], a[60:63], v[28:31], v[92:95]
    ds_read_b128 a[28:31], v7 offset:4096
    v_mfma_f32_16x16x32_bf16 v[96:99], a[32:35], v[32:35], v[96:99]
    v_mfma_f32_16x16x32_bf16 v[100:103], a[36:39], v[32:35], v[100:103]
    s_add_u32 m0, s59, 49152
    s_mov_b32 s66, 16384
    buffer_load_dwordx4 v222, s[44:47], s66 offen offset:0 nt lds
    v_mfma_f32_16x16x32_bf16 v[104:107], a[40:43], v[32:35], v[104:107]
    v_mul_f32 v64, s68, v64
    v_mul_f32 v65, s68, v65
    v_mul_f32 v66, s68, v66
    v_mul_f32 v67, s68, v67
    v_mfma_f32_16x16x32_bf16 v[108:111], a[44:47], v[32:35], v[108:111]
    v_mul_f32 v68, s68, v68
    v_mul_f32 v69, s68, v69
    v_mul_f32 v70, s68, v70
    v_mul_f32 v71, s68, v71
    v_mfma_f32_16x16x32_bf16 v[112:115], a[48:51], v[32:35], v[112:115]
    v_mul_f32 v72, s68, v72
    v_mul_f32 v73, s68, v73
    v_mul_f32 v74, s68, v74
    v_mul_f32 v75, s68, v75
    v_mfma_f32_16x16x32_bf16 v[116:119], a[52:55], v[32:35], v[116:119]
    s_add_u32 m0, s59, 49152
    s_mov_b32 s66, 16384
    buffer_load_dwordx4 v223, s[44:47], s66 offen offset:1024 nt lds
    v_mul_f32 v76, s68, v76
    v_mul_f32 v77, s68, v77
    v_mul_f32 v78, s68, v78
    v_mul_f32 v79, s68, v79
    v_mfma_f32_16x16x32_bf16 v[120:123], a[56:59], v[32:35], v[120:123]
    v_cvt_pk_bf16_f32 v172, v64, v65
    v_cvt_pk_bf16_f32 v173, v66, v67
    v_cvt_pk_bf16_f32 v174, v68, v69
    v_cvt_pk_bf16_f32 v175, v70, v71
    v_mfma_f32_16x16x32_bf16 v[124:127], a[60:63], v[32:35], v[124:127]
    v_mul_f32 v80, s68, v80
    v_mul_f32 v81, s68, v81
    v_mul_f32 v82, s68, v82
    v_mul_f32 v83, s68, v83
    v_mfma_f32_16x16x32_bf16 v[128:131], a[32:35], v[36:39], v[128:131]
    v_mul_f32 v84, s68, v84
    v_mul_f32 v85, s68, v85
    v_mul_f32 v86, s68, v86
    v_mul_f32 v87, s68, v87
    v_mfma_f32_16x16x32_bf16 v[132:135], a[36:39], v[36:39], v[132:135]
    v_cvt_pk_bf16_f32 v176, v72, v73
    v_cvt_pk_bf16_f32 v177, v74, v75
    v_cvt_pk_bf16_f32 v178, v76, v77
    v_cvt_pk_bf16_f32 v179, v78, v79
    v_mfma_f32_16x16x32_bf16 v[136:139], a[40:43], v[36:39], v[136:139]
    v_mul_f32 v88, s68, v88
    v_mul_f32 v89, s68, v89
    v_mul_f32 v90, s68, v90
    v_mul_f32 v91, s68, v91
    v_mfma_f32_16x16x32_bf16 v[140:143], a[44:47], v[36:39], v[140:143]
    v_mul_f32 v92, s68, v92
    v_mul_f32 v93, s68, v93
    v_mul_f32 v94, s68, v94
    v_mul_f32 v95, s68, v95
    v_mfma_f32_16x16x32_bf16 v[144:147], a[48:51], v[36:39], v[144:147]
    v_cvt_pk_bf16_f32 v180, v80, v81
    v_cvt_pk_bf16_f32 v181, v82, v83
    v_cvt_pk_bf16_f32 v182, v84, v85
    v_cvt_pk_bf16_f32 v183, v86, v87
    v_mfma_f32_16x16x32_bf16 v[148:151], a[52:55], v[36:39], v[148:151]
    v_cvt_pk_bf16_f32 v184, v88, v89
    v_cvt_pk_bf16_f32 v185, v90, v91
    v_cvt_pk_bf16_f32 v186, v92, v93
    v_cvt_pk_bf16_f32 v187, v94, v95
    v_mfma_f32_16x16x32_bf16 v[152:155], a[56:59], v[36:39], v[152:155]
    v_mul_f32 v96, s68, v96
    v_mul_f32 v97, s68, v97
    v_mul_f32 v98, s68, v98
    v_mul_f32 v99, s68, v99
    v_mul_f32 v100, s68, v100
    v_mul_f32 v101, s68, v101
    v_mfma_f32_16x16x32_bf16 v[156:159], a[60:63], v[36:39], v[156:159]
    s_waitcnt lgkmcnt(0)
    v_mul_f32 v102, s68, v102
    v_mul_f32 v103, s68, v103
    v_mul_f32 v104, s68, v104
    v_mul_f32 v105, s68, v105
    v_mul_f32 v106, s68, v106
    v_mfma_f32_16x16x32_bf16 v[16:19], a[0:3], v[172:175], 0
    ds_read_b64_tr_b16 a[32:33], v8 offset:0
    v_mul_f32 v107, s68, v107
    v_mul_f32 v108, s68, v108
    v_mul_f32 v109, s68, v109
    v_mul_f32 v110, s68, v110
    v_mul_f32 v111, s68, v111
    v_mfma_f32_16x16x32_bf16 v[16:19], a[4:7], v[176:179], v[16:19]
    ds_read_b64_tr_b16 a[34:35], v8 offset:4096
    v_cvt_pk_bf16_f32 v188, v96, v97
    v_cvt_pk_bf16_f32 v189, v98, v99
    v_cvt_pk_bf16_f32 v190, v100, v101
    v_cvt_pk_bf16_f32 v191, v102, v103
    v_mul_f32 v112, s68, v112
    v_mul_f32 v113, s68, v113
    v_mfma_f32_16x16x32_bf16 v[16:19], a[8:11], v[180:183], v[16:19]
    ds_read_b64_tr_b16 a[36:37], v9 offset:0
    v_mul_f32 v114, s68, v114
    v_mul_f32 v115, s68, v115
    v_mul_f32 v116, s68, v116
    v_mul_f32 v117, s68, v117
    v_mul_f32 v118, s68, v118
    v_mfma_f32_16x16x32_bf16 v[16:19], a[12:15], v[184:187], v[16:19]
    ds_read_b64_tr_b16 a[38:39], v9 offset:4096
    v_mul_f32 v119, s68, v119
    v_cvt_pk_bf16_f32 v192, v104, v105
    v_cvt_pk_bf16_f32 v193, v106, v107
    v_cvt_pk_bf16_f32 v194, v108, v109
    v_cvt_pk_bf16_f32 v195, v110, v111
    v_mfma_f32_16x16x32_bf16 v[20:23], a[16:19], v[172:175], 0
    ds_read_b64_tr_b16 a[40:41], v10 offset:0
    v_mul_f32 v120, s68, v120
    v_mul_f32 v121, s68, v121
    v_mul_f32 v122, s68, v122
    v_mul_f32 v123, s68, v123
    v_mul_f32 v124, s68, v124
    v_mul_f32 v125, s68, v125
    v_mfma_f32_16x16x32_bf16 v[20:23], a[20:23], v[176:179], v[20:23]
    ds_read_b64_tr_b16 a[42:43], v10 offset:4096
    v_mul_f32 v126, s68, v126
    v_mul_f32 v127, s68, v127
    v_cvt_pk_bf16_f32 v196, v112, v113
    v_cvt_pk_bf16_f32 v197, v114, v115
    v_cvt_pk_bf16_f32 v198, v116, v117
    v_mfma_f32_16x16x32_bf16 v[20:23], a[24:27], v[180:183], v[20:23]
    ds_read_b64_tr_b16 a[44:45], v11 offset:0
    v_cvt_pk_bf16_f32 v199, v118, v119
    v_cvt_pk_bf16_f32 v200, v120, v121
    v_cvt_pk_bf16_f32 v201, v122, v123
    v_cvt_pk_bf16_f32 v202, v124, v125
    v_cvt_pk_bf16_f32 v203, v126, v127
    v_mfma_f32_16x16x32_bf16 v[20:23], a[28:31], v[184:187], v[20:23]
    ds_read_b64_tr_b16 a[46:47], v11 offset:4096
    v_mul_f32 v128, s68, v128
    v_mul_f32 v129, s68, v129
    v_mul_f32 v130, s68, v130
    v_mul_f32 v131, s68, v131
    v_mul_f32 v132, s68, v132
    v_mul_f32 v133, s68, v133
    v_mfma_f32_16x16x32_bf16 v[24:27], a[0:3], v[188:191], 0
    ds_read_b64_tr_b16 a[48:49], v12 offset:0
    v_mul_f32 v134, s68, v134
    v_mul_f32 v135, s68, v135
    v_mul_f32 v136, s68, v136
    v_mul_f32 v137, s68, v137
    v_mul_f32 v138, s68, v138
    v_mul_f32 v139, s68, v139
    v_mfma_f32_16x16x32_bf16 v[24:27], a[4:7], v[192:195], v[24:27]
    ds_read_b64_tr_b16 a[50:51], v12 offset:4096
    v_mul_f32 v140, s68, v140
    v_mul_f32 v141, s68, v141
    v_mul_f32 v142, s68, v142
    v_mul_f32 v143, s68, v143
    v_cvt_pk_bf16_f32 v204, v128, v129
    v_cvt_pk_bf16_f32 v205, v130, v131
    v_mfma_f32_16x16x32_bf16 v[24:27], a[8:11], v[196:199], v[24:27]
    ds_read_b64_tr_b16 a[52:53], v13 offset:0
    v_cvt_pk_bf16_f32 v206, v132, v133
    v_cvt_pk_bf16_f32 v207, v134, v135
    v_mul_f32 v144, s68, v144
    v_mul_f32 v145, s68, v145
    v_mul_f32 v146, s68, v146
    v_mul_f32 v147, s68, v147
    v_mfma_f32_16x16x32_bf16 v[24:27], a[12:15], v[200:203], v[24:27]
    ds_read_b64_tr_b16 a[54:55], v13 offset:4096
    v_mul_f32 v148, s68, v148
    v_mul_f32 v149, s68, v149
    v_mul_f32 v150, s68, v150
    v_mul_f32 v151, s68, v151
    v_cvt_pk_bf16_f32 v208, v136, v137
    v_cvt_pk_bf16_f32 v209, v138, v139
    v_mfma_f32_16x16x32_bf16 v[28:31], a[16:19], v[188:191], 0
    ds_read_b64_tr_b16 a[56:57], v14 offset:0
    v_cvt_pk_bf16_f32 v210, v140, v141
    v_cvt_pk_bf16_f32 v211, v142, v143
    v_mul_f32 v152, s68, v152
    v_mul_f32 v153, s68, v153
    v_mul_f32 v154, s68, v154
    v_mul_f32 v155, s68, v155
    v_mfma_f32_16x16x32_bf16 v[28:31], a[20:23], v[192:195], v[28:31]
    ds_read_b64_tr_b16 a[58:59], v14 offset:4096
    v_mul_f32 v156, s68, v156
    v_mul_f32 v157, s68, v157
    v_mul_f32 v158, s68, v158
    v_mul_f32 v159, s68, v159
    v_cvt_pk_bf16_f32 v212, v144, v145
    v_cvt_pk_bf16_f32 v213, v146, v147
    v_mfma_f32_16x16x32_bf16 v[28:31], a[24:27], v[196:199], v[28:31]
    ds_read_b64_tr_b16 a[60:61], v15 offset:0
    v_cvt_pk_bf16_f32 v214, v148, v149
    v_cvt_pk_bf16_f32 v215, v150, v151
    v_cvt_pk_bf16_f32 v216, v152, v153
    v_cvt_pk_bf16_f32 v217, v154, v155
    v_cvt_pk_bf16_f32 v218, v156, v157
    v_cvt_pk_bf16_f32 v219, v158, v159
    v_mfma_f32_16x16x32_bf16 v[28:31], a[28:31], v[200:203], v[28:31]
    ds_read_b64_tr_b16 a[62:63], v15 offset:4096
    v_mov_b32 v168, 0
    v_mov_b32 v169, 0
    v_mov_b32 v170, 0
    v_mov_b32 v171, 0
    v_max3_f32 v241, v16, v17, v18
    v_max3_f32 v242, v19, v20, v21
    v_mfma_f32_16x16x32_bf16 v[32:35], a[0:3], v[204:207], 0
    v_max3_f32 v241, v241, v22, v23
    v_max_f32 v241, v241, v242
    v_mov_b32 v242, v241
    s_nop 1
    v_permlane16_swap_b32 v241, v242
    v_max_f32 v241, v241, v242
    v_mov_b32 v242, v241
    v_mfma_f32_16x16x32_bf16 v[32:35], a[4:7], v[208:211], v[32:35]
    s_nop 0
    v_permlane32_swap_b32 v241, v242
    v_max_f32 v241, v241, v242
    v_sub_f32 v16, v16, v241
    v_sub_f32 v17, v17, v241
    v_sub_f32 v18, v18, v241
    v_sub_f32 v19, v19, v241
    v_mfma_f32_16x16x32_bf16 v[32:35], a[8:11], v[212:215], v[32:35]
    v_sub_f32 v20, v20, v241
    v_sub_f32 v21, v21, v241
    v_sub_f32 v22, v22, v241
    v_sub_f32 v23, v23, v241
    v_sub_f32 v40, 0, v241
    v_mfma_f32_16x16x32_bf16 v[32:35], a[12:15], v[216:219], v[32:35]
    v_sub_f32 v41, 0, v241
    v_sub_f32 v42, 0, v241
    v_sub_f32 v43, 0, v241
    v_exp_f32 v16, v16
    v_exp_f32 v17, v17
    v_mfma_f32_16x16x32_bf16 v[36:39], a[16:19], v[204:207], 0
    v_exp_f32 v18, v18
    v_exp_f32 v19, v19
    v_exp_f32 v20, v20
    v_mfma_f32_16x16x32_bf16 v[36:39], a[20:23], v[208:211], v[36:39]
    v_exp_f32 v21, v21
    v_exp_f32 v22, v22
    v_exp_f32 v23, v23
    v_mfma_f32_16x16x32_bf16 v[36:39], a[24:27], v[212:215], v[36:39]
    v_cvt_pk_bf16_f32 v52, v16, v17
    v_cvt_pk_bf16_f32 v53, v18, v19
    v_cvt_pk_bf16_f32 v54, v20, v21
    v_cvt_pk_bf16_f32 v55, v22, v23
    v_mfma_f32_16x16x32_bf16 v[36:39], a[28:31], v[216:219], v[36:39]
    s_waitcnt lgkmcnt(0)
    v_max3_f32 v243, v24, v25, v26
    v_max3_f32 v244, v27, v28, v29
    v_max3_f32 v243, v243, v30, v31
    v_max_f32 v243, v243, v244
    v_mov_b32 v244, v243
    s_waitcnt vmcnt(4)
    s_waitcnt lgkmcnt(0)
    s_barrier
    v_mfma_f32_16x16x32_bf16 v[64:67], a[32:35], v[52:55], 0
    ds_read_b128 a[0:3], v4 offset:8192
    v_permlane16_swap_b32 v243, v244
    v_max_f32 v243, v243, v244
    v_mov_b32 v244, v243
    s_nop 1
    v_permlane32_swap_b32 v243, v244
    v_max_f32 v243, v243, v244
    v_mfma_f32_16x16x32_bf16 v[68:71], a[36:39], v[52:55], 0
    ds_read_b128 a[4:7], v5 offset:8192
    v_sub_f32 v24, v24, v243
    v_sub_f32 v25, v25, v243
    v_sub_f32 v26, v26, v243
    v_sub_f32 v27, v27, v243
    v_mfma_f32_16x16x32_bf16 v[72:75], a[40:43], v[52:55], 0
    ds_read_b128 a[8:11], v6 offset:8192
    v_sub_f32 v28, v28, v243
    v_sub_f32 v29, v29, v243
    v_sub_f32 v30, v30, v243
    v_sub_f32 v31, v31, v243
    v_sub_f32 v44, 0, v243
    v_mfma_f32_16x16x32_bf16 v[76:79], a[44:47], v[52:55], 0
    ds_read_b128 a[12:15], v7 offset:8192
    v_sub_f32 v45, 0, v243
    v_sub_f32 v46, 0, v243
    v_sub_f32 v47, 0, v243
    v_exp_f32 v24, v24
    v_mfma_f32_16x16x32_bf16 v[80:83], a[48:51], v[52:55], 0
    ds_read_b128 a[16:19], v4 offset:12288
    v_exp_f32 v25, v25
    v_exp_f32 v26, v26
    v_mfma_f32_16x16x32_bf16 v[84:87], a[52:55], v[52:55], 0
    ds_read_b128 a[20:23], v5 offset:12288
    v_exp_f32 v27, v27
    v_exp_f32 v28, v28
    v_exp_f32 v29, v29
    v_mfma_f32_16x16x32_bf16 v[88:91], a[56:59], v[52:55], 0
    ds_read_b128 a[24:27], v6 offset:12288
    v_exp_f32 v30, v30
    v_exp_f32 v31, v31
    v_mfma_f32_16x16x32_bf16 v[92:95], a[60:63], v[52:55], 0
    ds_read_b128 a[28:31], v7 offset:12288
    v_cvt_pk_bf16_f32 v56, v24, v25
    v_cvt_pk_bf16_f32 v57, v26, v27
    v_cvt_pk_bf16_f32 v58, v28, v29
    v_cvt_pk_bf16_f32 v59, v30, v31
    v_mfma_f32_16x16x32_bf16 v[160:163], a[64:67], v[52:55], 0
    v_max3_f32 v241, v32, v33, v34
    v_max3_f32 v242, v35, v36, v37
    v_max3_f32 v241, v241, v38, v39
    v_max_f32 v241, v241, v242
    v_mov_b32 v242, v241
    v_mfma_f32_16x16x32_bf16 v[96:99], a[32:35], v[56:59], 0
    s_nop 0
    v_permlane16_swap_b32 v241, v242
    v_max_f32 v241, v241, v242
    v_mov_b32 v242, v241
    s_nop 1
    v_permlane32_swap_b32 v241, v242
    v_max_f32 v241, v241, v242
    v_mfma_f32_16x16x32_bf16 v[100:103], a[36:39], v[56:59], 0
    v_sub_f32 v32, v32, v241
    v_sub_f32 v33, v33, v241
    v_sub_f32 v34, v34, v241
    v_sub_f32 v35, v35, v241
    v_sub_f32 v36, v36, v241
    v_mfma_f32_16x16x32_bf16 v[104:107], a[40:43], v[56:59], 0
    v_sub_f32 v37, v37, v241
    v_sub_f32 v38, v38, v241
    v_sub_f32 v39, v39, v241
    v_sub_f32 v48, 0, v241
    v_sub_f32 v49, 0, v241
    v_mfma_f32_16x16x32_bf16 v[108:111], a[44:47], v[56:59], 0
    v_sub_f32 v50, 0, v241
    v_sub_f32 v51, 0, v241
    v_exp_f32 v32, v32
    v_mfma_f32_16x16x32_bf16 v[112:115], a[48:51], v[56:59], 0
    v_exp_f32 v33, v33
    v_exp_f32 v34, v34
    v_exp_f32 v35, v35
    v_mfma_f32_16x16x32_bf16 v[116:119], a[52:55], v[56:59], 0
    v_exp_f32 v36, v36
    v_mov_b64 v[128:129], 0
    v_mov_b64 v[130:131], 0
    v_mfma_f32_16x16x32_bf16 v[120:123], a[56:59], v[56:59], 0
    v_mov_b64 v[132:133], 0
    v_mov_b64 v[134:135], 0
    v_mov_b64 v[136:137], 0
    v_mov_b64 v[138:139], 0
    v_mov_b64 v[140:141], 0
    v_mfma_f32_16x16x32_bf16 v[124:127], a[60:63], v[56:59], 0
    v_mov_b64 v[142:143], 0
    v_mov_b64 v[144:145], 0
    v_mov_b64 v[146:147], 0
    v_mov_b64 v[148:149], 0
    v_mov_b64 v[150:151], 0
    v_mfma_f32_16x16x32_bf16 v[164:167], a[64:67], v[56:59], 0
    v_mov_b64 v[152:153], 0
    v_mov_b64 v[154:155], 0
    v_mov_b64 v[156:157], 0
    v_mov_b64 v[158:159], 0
    s_mov_b32 s58, 8192
    s_mov_b32 s60, 0
    v_mov_b32 v250, 1
    s_and_b32 s96, s2, 1
    s_lshl_b32 s96, s96, 7
    s_lshr_b32 s67, s2, 6
    s_cmp_eq_u32 s52, 0
    s_cselect_b32 s67, s67, -1
    s_waitcnt lgkmcnt(0)
    s_branch L1_t1
.p2align 6
L1_t0:
    v_mfma_f32_16x16x32_bf16 v[16:19], a[0:3], v[172:175], v[40:43]
    v_exp_f32 v37, v37
    v_mfma_f32_16x16x32_bf16 v[16:19], a[4:7], v[176:179], v[16:19]
    v_exp_f32 v38, v38
    v_mfma_f32_16x16x32_bf16 v[16:19], a[8:11], v[180:183], v[16:19]
    v_exp_f32 v39, v39
    v_mfma_f32_16x16x32_bf16 v[16:19], a[12:15], v[184:187], v[16:19]
    v_cvt_pk_bf16_f32 v60, v32, v33
    v_cvt_pk_bf16_f32 v61, v34, v35
    v_mfma_f32_16x16x32_bf16 v[20:23], a[16:19], v[172:175], v[40:43]
    v_cvt_pk_bf16_f32 v62, v36, v37
    v_cvt_pk_bf16_f32 v63, v38, v39
    v_mfma_f32_16x16x32_bf16 v[20:23], a[20:23], v[176:179], v[20:23]
    s_nop 0
    v_mfma_f32_16x16x32_bf16 v[20:23], a[24:27], v[180:183], v[20:23]
    v_exp_f32 v16, v16
    v_mfma_f32_16x16x32_bf16 v[20:23], a[28:31], v[184:187], v[20:23]
    v_exp_f32 v17, v17
    v_mfma_f32_16x16x32_bf16 v[128:131], a[32:35], v[60:63], v[128:131]
    ds_read_b64_tr_b16 a[32:33], v8 offset:0
    ds_read_b64_tr_b16 a[34:35], v8 offset:4096
    v_mfma_f32_16x16x32_bf16 v[132:135], a[36:39], v[60:63], v[132:135]
    v_exp_f32 v18, v18
    v_mfma_f32_16x16x32_bf16 v[136:139], a[40:43], v[60:63], v[136:139]
    ds_read_b64_tr_b16 a[36:37], v9 offset:0
    ds_read_b64_tr_b16 a[38:39], v9 offset:4096
    v_mfma_f32_16x16x32_bf16 v[140:143], a[44:47], v[60:63], v[140:143]
    v_exp_f32 v19, v19
    v_mfma_f32_16x16x32_bf16 v[144:147], a[48:51], v[60:63], v[144:147]
    ds_read_b64_tr_b16 a[40:41], v10 offset:0
    ds_read_b64_tr_b16 a[42:43], v10 offset:4096
    v_mfma_f32_16x16x32_bf16 v[148:151], a[52:55], v[60:63], v[148:151]
    v_exp_f32 v20, v20
    v_mfma_f32_16x16x32_bf16 v[152:155], a[56:59], v[60:63], v[152:155]
    ds_read_b64_tr_b16 a[44:45], v11 offset:0
    ds_read_b64_tr_b16 a[46:47], v11 offset:4096
    v_mfma_f32_16x16x32_bf16 v[156:159], a[60:63], v[60:63], v[156:159]
    v_exp_f32 v21, v21
    v_mfma_f32_16x16x32_bf16 v[168:171], a[64:67], v[60:63], v[168:171]
    ds_read_b64_tr_b16 a[48:49], v12 offset:0
    ds_read_b64_tr_b16 a[50:51], v12 offset:4096
    v_mfma_f32_16x16x32_bf16 v[24:27], a[0:3], v[188:191], v[44:47]
    v_exp_f32 v22, v22
    v_mfma_f32_16x16x32_bf16 v[24:27], a[4:7], v[192:195], v[24:27]
    ds_read_b64_tr_b16 a[52:53], v13 offset:0
    ds_read_b64_tr_b16 a[54:55], v13 offset:4096
    v_mfma_f32_16x16x32_bf16 v[24:27], a[8:11], v[196:199], v[24:27]
    v_exp_f32 v23, v23
    v_mfma_f32_16x16x32_bf16 v[24:27], a[12:15], v[200:203], v[24:27]
    ds_read_b64_tr_b16 a[56:57], v14 offset:0
    ds_read_b64_tr_b16 a[58:59], v14 offset:4096
    v_mfma_f32_16x16x32_bf16 v[28:31], a[16:19], v[188:191], v[44:47]
    v_cvt_pk_bf16_f32 v52, v16, v17
    v_cvt_pk_bf16_f32 v53, v18, v19
    v_mfma_f32_16x16x32_bf16 v[28:31], a[20:23], v[192:195], v[28:31]
    s_add_u32 m0, s59, 16384
    s_add_u32 s66, s58, 16384
    buffer_load_dwordx4 v220, s[40:43], s66 offen offset:0 nt lds
    v_cvt_pk_bf16_f32 v54, v20, v21
    v_cvt_pk_bf16_f32 v55, v22, v23
    v_mfma_f32_16x16x32_bf16 v[28:31], a[24:27], v[196:199], v[28:31]
    ds_read_b64_tr_b16 a[60:61], v15 offset:0
    ds_read_b64_tr_b16 a[62:63], v15 offset:4096
    v_mfma_f32_16x16x32_bf16 v[28:31], a[28:31], v[200:203], v[28:31]
    s_waitcnt lgkmcnt(4)
    v_exp_f32 v24, v24
    v_mfma_f32_16x16x32_bf16 v[64:67], a[32:35], v[52:55], v[64:67]
    v_exp_f32 v25, v25
    v_mfma_f32_16x16x32_bf16 v[68:71], a[36:39], v[52:55], v[68:71]
    s_add_u32 m0, s59, 16384
    s_add_u32 s66, s58, 16384
    buffer_load_dwordx4 v221, s[40:43], s66 offen offset:1024 nt lds
    v_exp_f32 v26, v26
    v_mfma_f32_16x16x32_bf16 v[72:75], a[40:43], v[52:55], v[72:75]
    v_exp_f32 v27, v27
    v_mfma_f32_16x16x32_bf16 v[76:79], a[44:47], v[52:55], v[76:79]
    v_exp_f32 v28, v28
    v_mfma_f32_16x16x32_bf16 v[80:83], a[48:51], v[52:55], v[80:83]
    v_exp_f32 v29, v29
    v_mfma_f32_16x16x32_bf16 v[84:87], a[52:55], v[52:55], v[84:87]
    s_waitcnt lgkmcnt(0)
    s_add_u32 m0, s59, 49152
    s_add_u32 s66, s58, 16384
    buffer_load_dwordx4 v222, s[44:47], s66 offen offset:0 nt lds
    v_exp_f32 v30, v30
    v_mfma_f32_16x16x32_bf16 v[88:91], a[56:59], v[52:55], v[88:91]
    v_exp_f32 v31, v31
    v_mfma_f32_16x16x32_bf16 v[92:95], a[60:63], v[52:55], v[92:95]
    v_cvt_pk_bf16_f32 v56, v24, v25
    v_cvt_pk_bf16_f32 v57, v26, v27
    v_mfma_f32_16x16x32_bf16 v[160:163], a[64:67], v[52:55], v[160:163]
    s_add_u32 m0, s59, 49152
    s_add_u32 s66, s58, 16384
    buffer_load_dwordx4 v223, s[44:47], s66 offen offset:1024 nt lds
    s_waitcnt vmcnt(4) lgkmcnt(0)
    s_barrier
    v_mfma_f32_16x16x32_bf16 v[32:35], a[0:3], v[204:207], v[48:51]
    ds_read_b128 a[0:3], v4 offset:8192
    v_mfma_f32_16x16x32_bf16 v[32:35], a[4:7], v[208:211], v[32:35]
    ds_read_b128 a[4:7], v5 offset:8192
    v_mfma_f32_16x16x32_bf16 v[32:35], a[8:11], v[212:215], v[32:35]
    ds_read_b128 a[8:11], v6 offset:8192
    v_mfma_f32_16x16x32_bf16 v[32:35], a[12:15], v[216:219], v[32:35]
    ds_read_b128 a[12:15], v7 offset:8192
    v_mfma_f32_16x16x32_bf16 v[36:39], a[16:19], v[204:207], v[48:51]
    ds_read_b128 a[16:19], v4 offset:12288
    v_cvt_pk_bf16_f32 v58, v28, v29
    v_mfma_f32_16x16x32_bf16 v[36:39], a[20:23], v[208:211], v[36:39]
    ds_read_b128 a[20:23], v5 offset:12288
    v_cvt_pk_bf16_f32 v59, v30, v31
    v_mfma_f32_16x16x32_bf16 v[36:39], a[24:27], v[212:215], v[36:39]
    ds_read_b128 a[24:27], v6 offset:12288
    v_mfma_f32_16x16x32_bf16 v[36:39], a[28:31], v[216:219], v[36:39]
    ds_read_b128 a[28:31], v7 offset:12288
    v_mfma_f32_16x16x32_bf16 v[96:99], a[32:35], v[56:59], v[96:99]
    v_mfma_f32_16x16x32_bf16 v[100:103], a[36:39], v[56:59], v[100:103]
    v_mfma_f32_16x16x32_bf16 v[104:107], a[40:43], v[56:59], v[104:107]
    v_mfma_f32_16x16x32_bf16 v[108:111], a[44:47], v[56:59], v[108:111]
    v_mfma_f32_16x16x32_bf16 v[112:115], a[48:51], v[56:59], v[112:115]
    v_exp_f32 v32, v32
    v_mfma_f32_16x16x32_bf16 v[116:119], a[52:55], v[56:59], v[116:119]
    v_exp_f32 v33, v33
    v_mfma_f32_16x16x32_bf16 v[120:123], a[56:59], v[56:59], v[120:123]
    v_exp_f32 v34, v34
    v_mfma_f32_16x16x32_bf16 v[124:127], a[60:63], v[56:59], v[124:127]
    s_waitcnt lgkmcnt(0)
    v_exp_f32 v35, v35
    v_mfma_f32_16x16x32_bf16 v[164:167], a[64:67], v[56:59], v[164:167]
    s_add_u32 s58, s58, 8192
    v_exp_f32 v36, v36
L1_t1:
    v_mfma_f32_16x16x32_bf16 v[16:19], a[0:3], v[172:175], v[40:43]
    v_exp_f32 v37, v37
    v_mfma_f32_16x16x32_bf16 v[16:19], a[4:7], v[176:179], v[16:19]
    v_exp_f32 v38, v38
    v_mfma_f32_16x16x32_bf16 v[16:19], a[8:11], v[180:183], v[16:19]
    v_exp_f32 v39, v39
    v_mfma_f32_16x16x32_bf16 v[16:19], a[12:15], v[184:187], v[16:19]
    v_cvt_pk_bf16_f32 v60, v32, v33
    v_cvt_pk_bf16_f32 v61, v34, v35
    v_mfma_f32_16x16x32_bf16 v[20:23], a[16:19], v[172:175], v[40:43]
    v_cvt_pk_bf16_f32 v62, v36, v37
    v_cvt_pk_bf16_f32 v63, v38, v39
    v_mfma_f32_16x16x32_bf16 v[20:23], a[20:23], v[176:179], v[20:23]
    s_nop 0
    v_mfma_f32_16x16x32_bf16 v[20:23], a[24:27], v[180:183], v[20:23]
    v_exp_f32 v16, v16
    v_mfma_f32_16x16x32_bf16 v[20:23], a[28:31], v[184:187], v[20:23]
    v_exp_f32 v17, v17
    v_mfma_f32_16x16x32_bf16 v[128:131], a[32:35], v[60:63], v[128:131]
    ds_read_b64_tr_b16 a[32:33], v8 offset:8192
    ds_read_b64_tr_b16 a[34:35], v8 offset:12288
    v_mfma_f32_16x16x32_bf16 v[132:135], a[36:39], v[60:63], v[132:135]
    v_exp_f32 v18, v18
    v_mfma_f32_16x16x32_bf16 v[136:139], a[40:43], v[60:63], v[136:139]
    ds_read_b64_tr_b16 a[36:37], v9 offset:8192
    ds_read_b64_tr_b16 a[38:39], v9 offset:12288
    v_mfma_f32_16x16x32_bf16 v[140:143], a[44:47], v[60:63], v[140:143]
    v_exp_f32 v19, v19
    v_mfma_f32_16x16x32_bf16 v[144:147], a[48:51], v[60:63], v[144:147]
    ds_read_b64_tr_b16 a[40:41], v10 offset:8192
    ds_read_b64_tr_b16 a[42:43], v10 offset:12288
    v_mfma_f32_16x16x32_bf16 v[148:151], a[52:55], v[60:63], v[148:151]
    v_exp_f32 v20, v20
    v_mfma_f32_16x16x32_bf16 v[152:155], a[56:59], v[60:63], v[152:155]
    ds_read_b64_tr_b16 a[44:45], v11 offset:8192
    ds_read_b64_tr_b16 a[46:47], v11 offset:12288
    v_mfma_f32_16x16x32_bf16 v[156:159], a[60:63], v[60:63], v[156:159]
    v_exp_f32 v21, v21
    v_mfma_f32_16x16x32_bf16 v[168:171], a[64:67], v[60:63], v[168:171]
    ds_read_b64_tr_b16 a[48:49], v12 offset:8192
    ds_read_b64_tr_b16 a[50:51], v12 offset:12288
    v_mfma_f32_16x16x32_bf16 v[24:27], a[0:3], v[188:191], v[44:47]
    v_exp_f32 v22, v22
    v_mfma_f32_16x16x32_bf16 v[24:27], a[4:7], v[192:195], v[24:27]
    ds_read_b64_tr_b16 a[52:53], v13 offset:8192
    ds_read_b64_tr_b16 a[54:55], v13 offset:12288
    v_mfma_f32_16x16x32_bf16 v[24:27], a[8:11], v[196:199], v[24:27]
    v_exp_f32 v23, v23
    v_mfma_f32_16x16x32_bf16 v[24:27], a[12:15], v[200:203], v[24:27]
    ds_read_b64_tr_b16 a[56:57], v14 offset:8192
    ds_read_b64_tr_b16 a[58:59], v14 offset:12288
    v_mfma_f32_16x16x32_bf16 v[28:31], a[16:19], v[188:191], v[44:47]
    v_cvt_pk_bf16_f32 v52, v16, v17
    v_cvt_pk_bf16_f32 v53, v18, v19
    v_mfma_f32_16x16x32_bf16 v[28:31], a[20:23], v[192:195], v[28:31]
    s_add_u32 m0, s59, 24576
    s_add_u32 s66, s58, 16384
    buffer_load_dwordx4 v220, s[40:43], s66 offen offset:0 nt lds
    v_cvt_pk_bf16_f32 v54, v20, v21
    v_cvt_pk_bf16_f32 v55, v22, v23
    v_mfma_f32_16x16x32_bf16 v[28:31], a[24:27], v[196:199], v[28:31]
    ds_read_b64_tr_b16 a[60:61], v15 offset:8192
    ds_read_b64_tr_b16 a[62:63], v15 offset:12288
    v_mfma_f32_16x16x32_bf16 v[28:31], a[28:31], v[200:203], v[28:31]
    s_waitcnt lgkmcnt(4)
    v_exp_f32 v24, v24
    v_mfma_f32_16x16x32_bf16 v[64:67], a[32:35], v[52:55], v[64:67]
    v_exp_f32 v25, v25
    v_mfma_f32_16x16x32_bf16 v[68:71], a[36:39], v[52:55], v[68:71]
    s_add_u32 m0, s59, 24576
    s_add_u32 s66, s58, 16384
    buffer_load_dwordx4 v221, s[40:43], s66 offen offset:1024 nt lds
    v_exp_f32 v26, v26
    v_mfma_f32_16x16x32_bf16 v[72:75], a[40:43], v[52:55], v[72:75]
    v_exp_f32 v27, v27
    v_mfma_f32_16x16x32_bf16 v[76:79], a[44:47], v[52:55], v[76:79]
    v_exp_f32 v28, v28
    v_mfma_f32_16x16x32_bf16 v[80:83], a[48:51], v[52:55], v[80:83]
    v_exp_f32 v29, v29
    v_mfma_f32_16x16x32_bf16 v[84:87], a[52:55], v[52:55], v[84:87]
    s_waitcnt lgkmcnt(0)
    s_add_u32 m0, s59, 57344
    s_add_u32 s66, s58, 16384
    buffer_load_dwordx4 v222, s[44:47], s66 offen offset:0 nt lds
    v_exp_f32 v30, v30
    v_mfma_f32_16x16x32_bf16 v[88:91], a[56:59], v[52:55], v[88:91]
    v_exp_f32 v31, v31
    v_mfma_f32_16x16x32_bf16 v[92:95], a[60:63], v[52:55], v[92:95]
    v_cvt_pk_bf16_f32 v56, v24, v25
    v_cvt_pk_bf16_f32 v57, v26, v27
    v_mfma_f32_16x16x32_bf16 v[160:163], a[64:67], v[52:55], v[160:163]
    s_add_u32 m0, s59, 57344
    s_add_u32 s66, s58, 16384
    buffer_load_dwordx4 v223, s[44:47], s66 offen offset:1024 nt lds
    s_waitcnt vmcnt(4) lgkmcnt(0)
    s_barrier
    v_mfma_f32_16x16x32_bf16 v[32:35], a[0:3], v[204:207], v[48:51]
    ds_read_b128 a[0:3], v4 offset:16384
    v_mfma_f32_16x16x32_bf16 v[32:35], a[4:7], v[208:211], v[32:35]
    ds_read_b128 a[4:7], v5 offset:16384
    v_mfma_f32_16x16x32_bf16 v[32:35], a[8:11], v[212:215], v[32:35]
    ds_read_b128 a[8:11], v6 offset:16384
    v_mfma_f32_16x16x32_bf16 v[32:35], a[12:15], v[216:219], v[32:35]
    ds_read_b128 a[12:15], v7 offset:16384
    v_mfma_f32_16x16x32_bf16 v[36:39], a[16:19], v[204:207], v[48:51]
    ds_read_b128 a[16:19], v4 offset:20480
    v_cvt_pk_bf16_f32 v58, v28, v29
    v_mfma_f32_16x16x32_bf16 v[36:39], a[20:23], v[208:211], v[36:39]
    ds_read_b128 a[20:23], v5 offset:20480
    v_cvt_pk_bf16_f32 v59, v30, v31
    v_mfma_f32_16x16x32_bf16 v[36:39], a[24:27], v[212:215], v[36:39]
    ds_read_b128 a[24:27], v6 offset:20480
    v_mfma_f32_16x16x32_bf16 v[36:39], a[28:31], v[216:219], v[36:39]
    ds_read_b128 a[28:31], v7 offset:20480
    v_mfma_f32_16x16x32_bf16 v[96:99], a[32:35], v[56:59], v[96:99]
    v_mfma_f32_16x16x32_bf16 v[100:103], a[36:39], v[56:59], v[100:103]
    s_cmp_lg_u32 s67, s60
    s_cbranch_scc1 L1_cnt
    s_mov_b64 exec, 1
    buffer_atomic_add v250, off, s[84:87], s96 sc1
    s_mov_b64 exec, -1
L1_cnt:
    v_mfma_f32_16x16x32_bf16 v[104:107], a[40:43], v[56:59], v[104:107]
    v_mfma_f32_16x16x32_bf16 v[108:111], a[44:47], v[56:59], v[108:111]
    v_mfma_f32_16x16x32_bf16 v[112:115], a[48:51], v[56:59], v[112:115]
    v_exp_f32 v32, v32
    v_mfma_f32_16x16x32_bf16 v[116:119], a[52:55], v[56:59], v[116:119]
    v_exp_f32 v33, v33
    v_mfma_f32_16x16x32_bf16 v[120:123], a[56:59], v[56:59], v[120:123]
    v_exp_f32 v34, v34
    v_mfma_f32_16x16x32_bf16 v[124:127], a[60:63], v[56:59], v[124:127]
    s_waitcnt lgkmcnt(0)
    v_exp_f32 v35, v35
    v_mfma_f32_16x16x32_bf16 v[164:167], a[64:67], v[56:59], v[164:167]
    s_add_u32 s58, s58, 8192
    v_exp_f32 v36, v36
    v_mfma_f32_16x16x32_bf16 v[16:19], a[0:3], v[172:175], v[40:43]
    v_exp_f32 v37, v37
    v_mfma_f32_16x16x32_bf16 v[16:19], a[4:7], v[176:179], v[16:19]
    v_exp_f32 v38, v38
    v_mfma_f32_16x16x32_bf16 v[16:19], a[8:11], v[180:183], v[16:19]
    v_exp_f32 v39, v39
    v_mfma_f32_16x16x32_bf16 v[16:19], a[12:15], v[184:187], v[16:19]
    v_cvt_pk_bf16_f32 v60, v32, v33
    v_cvt_pk_bf16_f32 v61, v34, v35
    v_mfma_f32_16x16x32_bf16 v[20:23], a[16:19], v[172:175], v[40:43]
    v_cvt_pk_bf16_f32 v62, v36, v37
    v_cvt_pk_bf16_f32 v63, v38, v39
    v_mfma_f32_16x16x32_bf16 v[20:23], a[20:23], v[176:179], v[20:23]
    s_nop 0
    v_mfma_f32_16x16x32_bf16 v[20:23], a[24:27], v[180:183], v[20:23]
    v_exp_f32 v16, v16
    v_mfma_f32_16x16x32_bf16 v[20:23], a[28:31], v[184:187], v[20:23]
    v_exp_f32 v17, v17
    v_mfma_f32_16x16x32_bf16 v[128:131], a[32:35], v[60:63], v[128:131]
    ds_read_b64_tr_b16 a[32:33], v8 offset:16384
    ds_read_b64_tr_b16 a[34:35], v8 offset:20480
    v_mfma_f32_16x16x32_bf16 v[132:135], a[36:39], v[60:63], v[132:135]
    v_exp_f32 v18, v18
    v_mfma_f32_16x16x32_bf16 v[136:139], a[40:43], v[60:63], v[136:139]
    ds_read_b64_tr_b16 a[36:37], v9 offset:16384
    ds_read_b64_tr_b16 a[38:39], v9 offset:20480
    v_mfma_f32_16x16x32_bf16 v[140:143], a[44:47], v[60:63], v[140:143]
    v_exp_f32 v19, v19
    v_mfma_f32_16x16x32_bf16 v[144:147], a[48:51], v[60:63], v[144:147]
    ds_read_b64_tr_b16 a[40:41], v10 offset:16384
    ds_read_b64_tr_b16 a[42:43], v10 offset:20480
    v_mfma_f32_16x16x32_bf16 v[148:151], a[52:55], v[60:63], v[148:151]
    v_exp_f32 v20, v20
    v_mfma_f32_16x16x32_bf16 v[152:155], a[56:59], v[60:63], v[152:155]
    ds_read_b64_tr_b16 a[44:45], v11 offset:16384
    ds_read_b64_tr_b16 a[46:47], v11 offset:20480
    v_mfma_f32_16x16x32_bf16 v[156:159], a[60:63], v[60:63], v[156:159]
    v_exp_f32 v21, v21
    v_mfma_f32_16x16x32_bf16 v[168:171], a[64:67], v[60:63], v[168:171]
    ds_read_b64_tr_b16 a[48:49], v12 offset:16384
    ds_read_b64_tr_b16 a[50:51], v12 offset:20480
    v_mfma_f32_16x16x32_bf16 v[24:27], a[0:3], v[188:191], v[44:47]
    v_exp_f32 v22, v22
    v_mfma_f32_16x16x32_bf16 v[24:27], a[4:7], v[192:195], v[24:27]
    ds_read_b64_tr_b16 a[52:53], v13 offset:16384
    ds_read_b64_tr_b16 a[54:55], v13 offset:20480
    v_mfma_f32_16x16x32_bf16 v[24:27], a[8:11], v[196:199], v[24:27]
    v_exp_f32 v23, v23
    v_mfma_f32_16x16x32_bf16 v[24:27], a[12:15], v[200:203], v[24:27]
    ds_read_b64_tr_b16 a[56:57], v14 offset:16384
    ds_read_b64_tr_b16 a[58:59], v14 offset:20480
    v_mfma_f32_16x16x32_bf16 v[28:31], a[16:19], v[188:191], v[44:47]
    v_cvt_pk_bf16_f32 v52, v16, v17
    v_cvt_pk_bf16_f32 v53, v18, v19
    v_mfma_f32_16x16x32_bf16 v[28:31], a[20:23], v[192:195], v[28:31]
    s_add_u32 m0, s59, 0
    s_add_u32 s66, s58, 16384
    buffer_load_dwordx4 v220, s[40:43], s66 offen offset:0 nt lds
    v_cvt_pk_bf16_f32 v54, v20, v21
    v_cvt_pk_bf16_f32 v55, v22, v23
    v_mfma_f32_16x16x32_bf16 v[28:31], a[24:27], v[196:199], v[28:31]
    ds_read_b64_tr_b16 a[60:61], v15 offset:16384
    ds_read_b64_tr_b16 a[62:63], v15 offset:20480
    v_mfma_f32_16x16x32_bf16 v[28:31], a[28:31], v[200:203], v[28:31]
    s_waitcnt lgkmcnt(4)
    v_exp_f32 v24, v24
    v_mfma_f32_16x16x32_bf16 v[64:67], a[32:35], v[52:55], v[64:67]
    v_exp_f32 v25, v25
    v_mfma_f32_16x16x32_bf16 v[68:71], a[36:39], v[52:55], v[68:71]
    s_add_u32 m0, s59, 0
    s_add_u32 s66, s58, 16384
    buffer_load_dwordx4 v221, s[40:43], s66 offen offset:1024 nt lds
    v_exp_f32 v26, v26
    v_mfma_f32_16x16x32_bf16 v[72:75], a[40:43], v[52:55], v[72:75]
    v_exp_f32 v27, v27
    v_mfma_f32_16x16x32_bf16 v[76:79], a[44:47], v[52:55], v[76:79]
    v_exp_f32 v28, v28
    v_mfma_f32_16x16x32_bf16 v[80:83], a[48:51], v[52:55], v[80:83]
    v_exp_f32 v29, v29
    v_mfma_f32_16x16x32_bf16 v[84:87], a[52:55], v[52:55], v[84:87]
    s_waitcnt lgkmcnt(0)
    s_add_u32 m0, s59, 32768
    s_add_u32 s66, s58, 16384
    buffer_load_dwordx4 v222, s[44:47], s66 offen offset:0 nt lds
    v_exp_f32 v30, v30
    v_mfma_f32_16x16x32_bf16 v[88:91], a[56:59], v[52:55], v[88:91]
    v_exp_f32 v31, v31
    v_mfma_f32_16x16x32_bf16 v[92:95], a[60:63], v[52:55], v[92:95]
    v_cvt_pk_bf16_f32 v56, v24, v25
    v_cvt_pk_bf16_f32 v57, v26, v27
    v_mfma_f32_16x16x32_bf16 v[160:163], a[64:67], v[52:55], v[160:163]
    s_add_u32 m0, s59, 32768
    s_add_u32 s66, s58, 16384
    buffer_load_dwordx4 v223, s[44:47], s66 offen offset:1024 nt lds
    s_waitcnt vmcnt(4) lgkmcnt(0)
    s_barrier
    v_mfma_f32_16x16x32_bf16 v[32:35], a[0:3], v[204:207], v[48:51]
    ds_read_b128 a[0:3], v4 offset:24576
    v_mfma_f32_16x16x32_bf16 v[32:35], a[4:7], v[208:211], v[32:35]
    ds_read_b128 a[4:7], v5 offset:24576
    v_mfma_f32_16x16x32_bf16 v[32:35], a[8:11], v[212:215], v[32:35]
    ds_read_b128 a[8:11], v6 offset:24576
    v_mfma_f32_16x16x32_bf16 v[32:35], a[12:15], v[216:219], v[32:35]
    ds_read_b128 a[12:15], v7 offset:24576
    v_mfma_f32_16x16x32_bf16 v[36:39], a[16:19], v[204:207], v[48:51]
    ds_read_b128 a[16:19], v4 offset:28672
    v_cvt_pk_bf16_f32 v58, v28, v29
    v_mfma_f32_16x16x32_bf16 v[36:39], a[20:23], v[208:211], v[36:39]
    ds_read_b128 a[20:23], v5 offset:28672
    v_cvt_pk_bf16_f32 v59, v30, v31
    v_mfma_f32_16x16x32_bf16 v[36:39], a[24:27], v[212:215], v[36:39]
    ds_read_b128 a[24:27], v6 offset:28672
    v_mfma_f32_16x16x32_bf16 v[36:39], a[28:31], v[216:219], v[36:39]
    ds_read_b128 a[28:31], v7 offset:28672
    v_mfma_f32_16x16x32_bf16 v[96:99], a[32:35], v[56:59], v[96:99]
    v_mfma_f32_16x16x32_bf16 v[100:103], a[36:39], v[56:59], v[100:103]
    v_mfma_f32_16x16x32_bf16 v[104:107], a[40:43], v[56:59], v[104:107]
    v_mfma_f32_16x16x32_bf16 v[108:111], a[44:47], v[56:59], v[108:111]
    v_mfma_f32_16x16x32_bf16 v[112:115], a[48:51], v[56:59], v[112:115]
    v_exp_f32 v32, v32
    v_mfma_f32_16x16x32_bf16 v[116:119], a[52:55], v[56:59], v[116:119]
    v_exp_f32 v33, v33
    v_mfma_f32_16x16x32_bf16 v[120:123], a[56:59], v[56:59], v[120:123]
    v_exp_f32 v34, v34
    v_mfma_f32_16x16x32_bf16 v[124:127], a[60:63], v[56:59], v[124:127]
    s_waitcnt lgkmcnt(0)
    v_exp_f32 v35, v35
    v_mfma_f32_16x16x32_bf16 v[164:167], a[64:67], v[56:59], v[164:167]
    s_add_u32 s58, s58, 8192
    v_exp_f32 v36, v36
    v_mfma_f32_16x16x32_bf16 v[16:19], a[0:3], v[172:175], v[40:43]
    v_exp_f32 v37, v37
    v_mfma_f32_16x16x32_bf16 v[16:19], a[4:7], v[176:179], v[16:19]
    v_exp_f32 v38, v38
    v_mfma_f32_16x16x32_bf16 v[16:19], a[8:11], v[180:183], v[16:19]
    v_exp_f32 v39, v39
    v_mfma_f32_16x16x32_bf16 v[16:19], a[12:15], v[184:187], v[16:19]
    v_cvt_pk_bf16_f32 v60, v32, v33
    v_cvt_pk_bf16_f32 v61, v34, v35
    v_mfma_f32_16x16x32_bf16 v[20:23], a[16:19], v[172:175], v[40:43]
    v_cvt_pk_bf16_f32 v62, v36, v37
    v_cvt_pk_bf16_f32 v63, v38, v39
    v_mfma_f32_16x16x32_bf16 v[20:23], a[20:23], v[176:179], v[20:23]
    s_nop 0
    v_mfma_f32_16x16x32_bf16 v[20:23], a[24:27], v[180:183], v[20:23]
    v_exp_f32 v16, v16
    v_mfma_f32_16x16x32_bf16 v[20:23], a[28:31], v[184:187], v[20:23]
    v_exp_f32 v17, v17
    v_mfma_f32_16x16x32_bf16 v[128:131], a[32:35], v[60:63], v[128:131]
    ds_read_b64_tr_b16 a[32:33], v8 offset:24576
    ds_read_b64_tr_b16 a[34:35], v8 offset:28672
    v_mfma_f32_16x16x32_bf16 v[132:135], a[36:39], v[60:63], v[132:135]
    v_exp_f32 v18, v18
    v_mfma_f32_16x16x32_bf16 v[136:139], a[40:43], v[60:63], v[136:139]
    ds_read_b64_tr_b16 a[36:37], v9 offset:24576
    ds_read_b64_tr_b16 a[38:39], v9 offset:28672
    v_mfma_f32_16x16x32_bf16 v[140:143], a[44:47], v[60:63], v[140:143]
    v_exp_f32 v19, v19
    v_mfma_f32_16x16x32_bf16 v[144:147], a[48:51], v[60:63], v[144:147]
    ds_read_b64_tr_b16 a[40:41], v10 offset:24576
    ds_read_b64_tr_b16 a[42:43], v10 offset:28672
    v_mfma_f32_16x16x32_bf16 v[148:151], a[52:55], v[60:63], v[148:151]
    v_exp_f32 v20, v20
    v_mfma_f32_16x16x32_bf16 v[152:155], a[56:59], v[60:63], v[152:155]
    ds_read_b64_tr_b16 a[44:45], v11 offset:24576
    ds_read_b64_tr_b16 a[46:47], v11 offset:28672
    v_mfma_f32_16x16x32_bf16 v[156:159], a[60:63], v[60:63], v[156:159]
    v_exp_f32 v21, v21
    v_mfma_f32_16x16x32_bf16 v[168:171], a[64:67], v[60:63], v[168:171]
    ds_read_b64_tr_b16 a[48:49], v12 offset:24576
    ds_read_b64_tr_b16 a[50:51], v12 offset:28672
    v_mfma_f32_16x16x32_bf16 v[24:27], a[0:3], v[188:191], v[44:47]
    v_exp_f32 v22, v22
    v_mfma_f32_16x16x32_bf16 v[24:27], a[4:7], v[192:195], v[24:27]
    ds_read_b64_tr_b16 a[52:53], v13 offset:24576
    ds_read_b64_tr_b16 a[54:55], v13 offset:28672
    v_mfma_f32_16x16x32_bf16 v[24:27], a[8:11], v[196:199], v[24:27]
    v_exp_f32 v23, v23
    v_mfma_f32_16x16x32_bf16 v[24:27], a[12:15], v[200:203], v[24:27]
    ds_read_b64_tr_b16 a[56:57], v14 offset:24576
    ds_read_b64_tr_b16 a[58:59], v14 offset:28672
    v_mfma_f32_16x16x32_bf16 v[28:31], a[16:19], v[188:191], v[44:47]
    v_cvt_pk_bf16_f32 v52, v16, v17
    v_cvt_pk_bf16_f32 v53, v18, v19
    v_mfma_f32_16x16x32_bf16 v[28:31], a[20:23], v[192:195], v[28:31]
    s_add_u32 m0, s59, 8192
    s_add_u32 s66, s58, 16384
    buffer_load_dwordx4 v220, s[40:43], s66 offen offset:0 nt lds
    v_cvt_pk_bf16_f32 v54, v20, v21
    v_cvt_pk_bf16_f32 v55, v22, v23
    v_mfma_f32_16x16x32_bf16 v[28:31], a[24:27], v[196:199], v[28:31]
    ds_read_b64_tr_b16 a[60:61], v15 offset:24576
    ds_read_b64_tr_b16 a[62:63], v15 offset:28672
    v_mfma_f32_16x16x32_bf16 v[28:31], a[28:31], v[200:203], v[28:31]
    s_waitcnt lgkmcnt(4)
    v_exp_f32 v24, v24
    v_mfma_f32_16x16x32_bf16 v[64:67], a[32:35], v[52:55], v[64:67]
    v_exp_f32 v25, v25
    v_mfma_f32_16x16x32_bf16 v[68:71], a[36:39], v[52:55], v[68:71]
    s_add_u32 m0, s59, 8192
    s_add_u32 s66, s58, 16384
    buffer_load_dwordx4 v221, s[40:43], s66 offen offset:1024 nt lds
    v_exp_f32 v26, v26
    v_mfma_f32_16x16x32_bf16 v[72:75], a[40:43], v[52:55], v[72:75]
    v_exp_f32 v27, v27
    v_mfma_f32_16x16x32_bf16 v[76:79], a[44:47], v[52:55], v[76:79]
    v_exp_f32 v28, v28
    v_mfma_f32_16x16x32_bf16 v[80:83], a[48:51], v[52:55], v[80:83]
    v_exp_f32 v29, v29
    v_mfma_f32_16x16x32_bf16 v[84:87], a[52:55], v[52:55], v[84:87]
    s_waitcnt lgkmcnt(0)
    s_add_u32 m0, s59, 40960
    s_add_u32 s66, s58, 16384
    buffer_load_dwordx4 v222, s[44:47], s66 offen offset:0 nt lds
    v_exp_f32 v30, v30
    v_mfma_f32_16x16x32_bf16 v[88:91], a[56:59], v[52:55], v[88:91]
    v_exp_f32 v31, v31
    v_mfma_f32_16x16x32_bf16 v[92:95], a[60:63], v[52:55], v[92:95]
    v_cvt_pk_bf16_f32 v56, v24, v25
    v_cvt_pk_bf16_f32 v57, v26, v27
    v_mfma_f32_16x16x32_bf16 v[160:163], a[64:67], v[52:55], v[160:163]
    s_add_u32 m0, s59, 40960
    s_add_u32 s66, s58, 16384
    buffer_load_dwordx4 v223, s[44:47], s66 offen offset:1024 nt lds
    s_waitcnt vmcnt(4) lgkmcnt(0)
    s_barrier
    v_mfma_f32_16x16x32_bf16 v[32:35], a[0:3], v[204:207], v[48:51]
    ds_read_b128 a[0:3], v4 offset:0
    v_mfma_f32_16x16x32_bf16 v[32:35], a[4:7], v[208:211], v[32:35]
    ds_read_b128 a[4:7], v5 offset:0
    v_mfma_f32_16x16x32_bf16 v[32:35], a[8:11], v[212:215], v[32:35]
    ds_read_b128 a[8:11], v6 offset:0
    v_mfma_f32_16x16x32_bf16 v[32:35], a[12:15], v[216:219], v[32:35]
    ds_read_b128 a[12:15], v7 offset:0
    v_mfma_f32_16x16x32_bf16 v[36:39], a[16:19], v[204:207], v[48:51]
    ds_read_b128 a[16:19], v4 offset:4096
    v_cvt_pk_bf16_f32 v58, v28, v29
    v_mfma_f32_16x16x32_bf16 v[36:39], a[20:23], v[208:211], v[36:39]
    ds_read_b128 a[20:23], v5 offset:4096
    v_cvt_pk_bf16_f32 v59, v30, v31
    v_mfma_f32_16x16x32_bf16 v[36:39], a[24:27], v[212:215], v[36:39]
    ds_read_b128 a[24:27], v6 offset:4096
    v_mfma_f32_16x16x32_bf16 v[36:39], a[28:31], v[216:219], v[36:39]
    ds_read_b128 a[28:31], v7 offset:4096
    v_mfma_f32_16x16x32_bf16 v[96:99], a[32:35], v[56:59], v[96:99]
    v_mfma_f32_16x16x32_bf16 v[100:103], a[36:39], v[56:59], v[100:103]
    v_mfma_f32_16x16x32_bf16 v[104:107], a[40:43], v[56:59], v[104:107]
    v_mfma_f32_16x16x32_bf16 v[108:111], a[44:47], v[56:59], v[108:111]
    v_mfma_f32_16x16x32_bf16 v[112:115], a[48:51], v[56:59], v[112:115]
    v_exp_f32 v32, v32
    v_mfma_f32_16x16x32_bf16 v[116:119], a[52:55], v[56:59], v[116:119]
    v_exp_f32 v33, v33
    v_mfma_f32_16x16x32_bf16 v[120:123], a[56:59], v[56:59], v[120:123]
    s_add_u32 s60, s60, 1
    v_exp_f32 v34, v34
    v_mfma_f32_16x16x32_bf16 v[124:127], a[60:63], v[56:59], v[124:127]
    s_waitcnt lgkmcnt(0)
    v_exp_f32 v35, v35
    v_mfma_f32_16x16x32_bf16 v[164:167], a[64:67], v[56:59], v[164:167]
    s_add_u32 s58, s58, 8192
    v_exp_f32 v36, v36
    s_cmp_lt_u32 s60, 7
    s_cbranch_scc1 L1_t0
L1_loopend:
    v_mfma_f32_16x16x32_bf16 v[16:19], a[0:3], v[172:175], v[40:43]
    v_exp_f32 v37, v37
    v_mfma_f32_16x16x32_bf16 v[16:19], a[4:7], v[176:179], v[16:19]
    v_exp_f32 v38, v38
    v_mfma_f32_16x16x32_bf16 v[16:19], a[8:11], v[180:183], v[16:19]
    v_exp_f32 v39, v39
    v_mfma_f32_16x16x32_bf16 v[16:19], a[12:15], v[184:187], v[16:19]
    v_cvt_pk_bf16_f32 v60, v32, v33
    v_cvt_pk_bf16_f32 v61, v34, v35
    v_and_b32 v247, 1, v0
    v_mfma_f32_16x16x32_bf16 v[20:23], a[16:19], v[172:175], v[40:43]
    v_cvt_pk_bf16_f32 v62, v36, v37
    v_cvt_pk_bf16_f32 v63, v38, v39
    v_mfma_f32_16x16x32_bf16 v[20:23], a[20:23], v[176:179], v[20:23]
    s_nop 0
    v_lshlrev_b32 v247, 7, v247
    v_mfma_f32_16x16x32_bf16 v[20:23], a[24:27], v[180:183], v[20:23]
    v_exp_f32 v16, v16
    v_mfma_f32_16x16x32_bf16 v[20:23], a[28:31], v[184:187], v[20:23]
    v_exp_f32 v17, v17
    v_mfma_f32_16x16x32_bf16 v[128:131], a[32:35], v[60:63], v[128:131]
    ds_read_b64_tr_b16 a[32:33], v8 offset:0
    ds_read_b64_tr_b16 a[34:35], v8 offset:4096
    v_lshlrev_b32 v245, 4, v0
    v_mfma_f32_16x16x32_bf16 v[132:135], a[36:39], v[60:63], v[132:135]
    s_mov_b32 s93, 0
    v_exp_f32 v18, v18
    v_mfma_f32_16x16x32_bf16 v[136:139], a[40:43], v[60:63], v[136:139]
    ds_read_b64_tr_b16 a[36:37], v9 offset:0
    ds_read_b64_tr_b16 a[38:39], v9 offset:4096
    s_mov_b32 s94, 131072
    v_mfma_f32_16x16x32_bf16 v[140:143], a[44:47], v[60:63], v[140:143]
    s_mov_b32 s95, 262144
    v_exp_f32 v19, v19
    v_mfma_f32_16x16x32_bf16 v[144:147], a[48:51], v[60:63], v[144:147]
    ds_read_b64_tr_b16 a[40:41], v10 offset:0
    ds_read_b64_tr_b16 a[42:43], v10 offset:4096
    v_mfma_f32_16x16x32_bf16 v[148:151], a[52:55], v[60:63], v[148:151]
    v_exp_f32 v20, v20
    v_mfma_f32_16x16x32_bf16 v[152:155], a[56:59], v[60:63], v[152:155]
    ds_read_b64_tr_b16 a[44:45], v11 offset:0
    ds_read_b64_tr_b16 a[46:47], v11 offset:4096
    v_mfma_f32_16x16x32_bf16 v[156:159], a[60:63], v[60:63], v[156:159]
    v_exp_f32 v21, v21
    v_mfma_f32_16x16x32_bf16 v[168:171], a[64:67], v[60:63], v[168:171]
    ds_read_b64_tr_b16 a[48:49], v12 offset:0
    ds_read_b64_tr_b16 a[50:51], v12 offset:4096
    v_mfma_f32_16x16x32_bf16 v[24:27], a[0:3], v[188:191], v[44:47]
    buffer_load_dword v248, v247, s[84:87], 0 offen sc1
    v_exp_f32 v22, v22
    v_mfma_f32_16x16x32_bf16 v[24:27], a[4:7], v[192:195], v[24:27]
    ds_read_b64_tr_b16 a[52:53], v13 offset:0
    ds_read_b64_tr_b16 a[54:55], v13 offset:4096
    v_mfma_f32_16x16x32_bf16 v[24:27], a[8:11], v[196:199], v[24:27]
    v_exp_f32 v23, v23
    v_mfma_f32_16x16x32_bf16 v[24:27], a[12:15], v[200:203], v[24:27]
    ds_read_b64_tr_b16 a[56:57], v14 offset:0
    ds_read_b64_tr_b16 a[58:59], v14 offset:4096
    v_mfma_f32_16x16x32_bf16 v[28:31], a[16:19], v[188:191], v[44:47]
    v_cvt_pk_bf16_f32 v52, v16, v17
    v_cvt_pk_bf16_f32 v53, v18, v19
    v_mfma_f32_16x16x32_bf16 v[28:31], a[20:23], v[192:195], v[28:31]
    s_add_u32 m0, s59, 16384
    s_mov_b32 s66, 245760
    buffer_load_dwordx4 v220, s[40:43], s66 offen offset:0 nt lds
    v_cvt_pk_bf16_f32 v54, v20, v21
    v_cvt_pk_bf16_f32 v55, v22, v23
    v_mfma_f32_16x16x32_bf16 v[28:31], a[24:27], v[196:199], v[28:31]
    ds_read_b64_tr_b16 a[60:61], v15 offset:0
    ds_read_b64_tr_b16 a[62:63], v15 offset:4096
    v_mfma_f32_16x16x32_bf16 v[28:31], a[28:31], v[200:203], v[28:31]
    s_waitcnt lgkmcnt(4)
    v_exp_f32 v24, v24
    v_mfma_f32_16x16x32_bf16 v[64:67], a[32:35], v[52:55], v[64:67]
    v_exp_f32 v25, v25
    v_mfma_f32_16x16x32_bf16 v[68:71], a[36:39], v[52:55], v[68:71]
    s_add_u32 m0, s59, 16384
    s_mov_b32 s66, 245760
    buffer_load_dwordx4 v221, s[40:43], s66 offen offset:1024 nt lds
    v_exp_f32 v26, v26
    v_mfma_f32_16x16x32_bf16 v[72:75], a[40:43], v[52:55], v[72:75]
    v_exp_f32 v27, v27
    v_mfma_f32_16x16x32_bf16 v[76:79], a[44:47], v[52:55], v[76:79]
    v_exp_f32 v28, v28
    v_mfma_f32_16x16x32_bf16 v[80:83], a[48:51], v[52:55], v[80:83]
    v_exp_f32 v29, v29
    v_mfma_f32_16x16x32_bf16 v[84:87], a[52:55], v[52:55], v[84:87]
    s_waitcnt lgkmcnt(0)
    s_add_u32 m0, s59, 49152
    s_mov_b32 s66, 245760
    buffer_load_dwordx4 v222, s[44:47], s66 offen offset:0 nt lds
    v_exp_f32 v30, v30
    v_mfma_f32_16x16x32_bf16 v[88:91], a[56:59], v[52:55], v[88:91]
    v_exp_f32 v31, v31
    v_mfma_f32_16x16x32_bf16 v[92:95], a[60:63], v[52:55], v[92:95]
    v_cvt_pk_bf16_f32 v56, v24, v25
    v_cvt_pk_bf16_f32 v57, v26, v27
    v_mfma_f32_16x16x32_bf16 v[160:163], a[64:67], v[52:55], v[160:163]
    s_add_u32 m0, s59, 49152
    s_mov_b32 s66, 245760
    buffer_load_dwordx4 v223, s[44:47], s66 offen offset:1024 nt lds
    s_waitcnt vmcnt(5) lgkmcnt(0)
    s_barrier
    v_mfma_f32_16x16x32_bf16 v[32:35], a[0:3], v[204:207], v[48:51]
    ds_read_b128 a[0:3], v4 offset:8192
    v_accvgpr_read_b32 v232, a76
    v_accvgpr_read_b32 v233, a77
    v_mfma_f32_16x16x32_bf16 v[32:35], a[4:7], v[208:211], v[32:35]
    ds_read_b128 a[4:7], v5 offset:8192
    v_accvgpr_read_b32 v234, a78
    v_mfma_f32_16x16x32_bf16 v[32:35], a[8:11], v[212:215], v[32:35]
    ds_read_b128 a[8:11], v6 offset:8192
    v_accvgpr_read_b32 v235, a79
    v_mfma_f32_16x16x32_bf16 v[32:35], a[12:15], v[216:219], v[32:35]
    ds_read_b128 a[12:15], v7 offset:8192
    v_accvgpr_read_b32 v224, a68
    v_accvgpr_read_b32 v225, a69
    v_mfma_f32_16x16x32_bf16 v[36:39], a[16:19], v[204:207], v[48:51]
    ds_read_b128 a[16:19], v4 offset:12288
    v_cvt_pk_bf16_f32 v58, v28, v29
    v_accvgpr_read_b32 v226, a70
    v_mfma_f32_16x16x32_bf16 v[36:39], a[20:23], v[208:211], v[36:39]
    ds_read_b128 a[20:23], v5 offset:12288
    v_cvt_pk_bf16_f32 v59, v30, v31
    v_accvgpr_read_b32 v227, a71
    v_mfma_f32_16x16x32_bf16 v[36:39], a[24:27], v[212:215], v[36:39]
    ds_read_b128 a[24:27], v6 offset:12288
    v_accvgpr_read_b32 v228, a72
    v_accvgpr_read_b32 v229, a73
    v_mfma_f32_16x16x32_bf16 v[36:39], a[28:31], v[216:219], v[36:39]
    ds_read_b128 a[28:31], v7 offset:12288
    v_accvgpr_read_b32 v230, a74
    v_mfma_f32_16x16x32_bf16 v[96:99], a[32:35], v[56:59], v[96:99]
    v_accvgpr_read_b32 v231, a75
    v_mfma_f32_16x16x32_bf16 v[100:103], a[36:39], v[56:59], v[100:103]
    v_accvgpr_read_b32 v236, a80
    v_accvgpr_read_b32 v237, a81
    v_mfma_f32_16x16x32_bf16 v[104:107], a[40:43], v[56:59], v[104:107]
    v_accvgpr_read_b32 v238, a82
    v_mfma_f32_16x16x32_bf16 v[108:111], a[44:47], v[56:59], v[108:111]
    v_accvgpr_read_b32 v239, a83
    v_mfma_f32_16x16x32_bf16 v[112:115], a[48:51], v[56:59], v[112:115]
    v_exp_f32 v32, v32
    v_mfma_f32_16x16x32_bf16 v[116:119], a[52:55], v[56:59], v[116:119]
    v_exp_f32 v33, v33
    v_mfma_f32_16x16x32_bf16 v[120:123], a[56:59], v[56:59], v[120:123]
    v_exp_f32 v34, v34
    v_mfma_f32_16x16x32_bf16 v[124:127], a[60:63], v[56:59], v[124:127]
    s_waitcnt lgkmcnt(0)
    v_exp_f32 v35, v35
    v_mfma_f32_16x16x32_bf16 v[164:167], a[64:67], v[56:59], v[164:167]
    v_exp_f32 v36, v36
    v_mfma_f32_16x16x32_bf16 v[16:19], a[0:3], v[172:175], v[40:43]
    v_exp_f32 v37, v37
    v_mfma_f32_16x16x32_bf16 v[16:19], a[4:7], v[176:179], v[16:19]
    v_exp_f32 v38, v38
    v_mfma_f32_16x16x32_bf16 v[16:19], a[8:11], v[180:183], v[16:19]
    v_exp_f32 v39, v39
    v_mfma_f32_16x16x32_bf16 v[16:19], a[12:15], v[184:187], v[16:19]
    v_cvt_pk_bf16_f32 v60, v32, v33
    v_cvt_pk_bf16_f32 v61, v34, v35
    v_mfma_f32_16x16x32_bf16 v[20:23], a[16:19], v[172:175], v[40:43]
    v_cvt_pk_bf16_f32 v62, v36, v37
    v_cvt_pk_bf16_f32 v63, v38, v39
    v_mfma_f32_16x16x32_bf16 v[20:23], a[20:23], v[176:179], v[20:23]
    s_nop 0
    v_mfma_f32_16x16x32_bf16 v[20:23], a[24:27], v[180:183], v[20:23]
    v_exp_f32 v16, v16
    v_mfma_f32_16x16x32_bf16 v[20:23], a[28:31], v[184:187], v[20:23]
    v_exp_f32 v17, v17
    v_mfma_f32_16x16x32_bf16 v[128:131], a[32:35], v[60:63], v[128:131]
    ds_read_b64_tr_b16 a[32:33], v8 offset:8192
    ds_read_b64_tr_b16 a[34:35], v8 offset:12288
    v_mfma_f32_16x16x32_bf16 v[132:135], a[36:39], v[60:63], v[132:135]
    v_exp_f32 v18, v18
    v_mfma_f32_16x16x32_bf16 v[136:139], a[40:43], v[60:63], v[136:139]
    ds_read_b64_tr_b16 a[36:37], v9 offset:8192
    ds_read_b64_tr_b16 a[38:39], v9 offset:12288
    v_mfma_f32_16x16x32_bf16 v[140:143], a[44:47], v[60:63], v[140:143]
    v_exp_f32 v19, v19
    v_mfma_f32_16x16x32_bf16 v[144:147], a[48:51], v[60:63], v[144:147]
    ds_read_b64_tr_b16 a[40:41], v10 offset:8192
    ds_read_b64_tr_b16 a[42:43], v10 offset:12288
    v_mfma_f32_16x16x32_bf16 v[148:151], a[52:55], v[60:63], v[148:151]
    v_exp_f32 v20, v20
    v_mfma_f32_16x16x32_bf16 v[152:155], a[56:59], v[60:63], v[152:155]
    ds_read_b64_tr_b16 a[44:45], v11 offset:8192
    ds_read_b64_tr_b16 a[46:47], v11 offset:12288
    v_mfma_f32_16x16x32_bf16 v[156:159], a[60:63], v[60:63], v[156:159]
    v_exp_f32 v21, v21
    v_mfma_f32_16x16x32_bf16 v[168:171], a[64:67], v[60:63], v[168:171]
    ds_read_b64_tr_b16 a[48:49], v12 offset:8192
    ds_read_b64_tr_b16 a[50:51], v12 offset:12288
    v_mfma_f32_16x16x32_bf16 v[24:27], a[0:3], v[188:191], v[44:47]
    v_exp_f32 v22, v22
    v_mfma_f32_16x16x32_bf16 v[24:27], a[4:7], v[192:195], v[24:27]
    ds_read_b64_tr_b16 a[52:53], v13 offset:8192
    ds_read_b64_tr_b16 a[54:55], v13 offset:12288
    v_mfma_f32_16x16x32_bf16 v[24:27], a[8:11], v[196:199], v[24:27]
    v_exp_f32 v23, v23
    v_mfma_f32_16x16x32_bf16 v[24:27], a[12:15], v[200:203], v[24:27]
    ds_read_b64_tr_b16 a[56:57], v14 offset:8192
    ds_read_b64_tr_b16 a[58:59], v14 offset:12288
    v_mfma_f32_16x16x32_bf16 v[28:31], a[16:19], v[188:191], v[44:47]
    v_cvt_pk_bf16_f32 v52, v16, v17
    v_cvt_pk_bf16_f32 v53, v18, v19
    v_mfma_f32_16x16x32_bf16 v[28:31], a[20:23], v[192:195], v[28:31]
    s_add_u32 m0, s59, 24576
    s_mov_b32 s66, 253952
    buffer_load_dwordx4 v220, s[40:43], s66 offen offset:0 nt lds
    v_cvt_pk_bf16_f32 v54, v20, v21
    v_cvt_pk_bf16_f32 v55, v22, v23
    v_mfma_f32_16x16x32_bf16 v[28:31], a[24:27], v[196:199], v[28:31]
    ds_read_b64_tr_b16 a[60:61], v15 offset:8192
    ds_read_b64_tr_b16 a[62:63], v15 offset:12288
    v_mfma_f32_16x16x32_bf16 v[28:31], a[28:31], v[200:203], v[28:31]
    s_waitcnt lgkmcnt(4)
    v_exp_f32 v24, v24
    v_mfma_f32_16x16x32_bf16 v[64:67], a[32:35], v[52:55], v[64:67]
    v_exp_f32 v25, v25
    v_mfma_f32_16x16x32_bf16 v[68:71], a[36:39], v[52:55], v[68:71]
    s_add_u32 m0, s59, 24576
    s_mov_b32 s66, 253952
    buffer_load_dwordx4 v221, s[40:43], s66 offen offset:1024 nt lds
    v_exp_f32 v26, v26
    v_mfma_f32_16x16x32_bf16 v[72:75], a[40:43], v[52:55], v[72:75]
    v_exp_f32 v27, v27
    v_mfma_f32_16x16x32_bf16 v[76:79], a[44:47], v[52:55], v[76:79]
    v_exp_f32 v28, v28
    v_mfma_f32_16x16x32_bf16 v[80:83], a[48:51], v[52:55], v[80:83]
    v_exp_f32 v29, v29
    v_mfma_f32_16x16x32_bf16 v[84:87], a[52:55], v[52:55], v[84:87]
    s_waitcnt lgkmcnt(0)
    s_add_u32 m0, s59, 57344
    s_mov_b32 s66, 253952
    buffer_load_dwordx4 v222, s[44:47], s66 offen offset:0 nt lds
    v_exp_f32 v30, v30
    v_mfma_f32_16x16x32_bf16 v[88:91], a[56:59], v[52:55], v[88:91]
    v_exp_f32 v31, v31
    v_mfma_f32_16x16x32_bf16 v[92:95], a[60:63], v[52:55], v[92:95]
    v_cvt_pk_bf16_f32 v56, v24, v25
    v_cvt_pk_bf16_f32 v57, v26, v27
    v_mfma_f32_16x16x32_bf16 v[160:163], a[64:67], v[52:55], v[160:163]
    s_add_u32 m0, s59, 57344
    s_mov_b32 s66, 253952
    buffer_load_dwordx4 v223, s[44:47], s66 offen offset:1024 nt lds
    s_waitcnt vmcnt(4) lgkmcnt(0)
    s_barrier
    v_mfma_f32_16x16x32_bf16 v[32:35], a[0:3], v[204:207], v[48:51]
    ds_read_b128 a[0:3], v4 offset:16384
    v_mfma_f32_16x16x32_bf16 v[32:35], a[4:7], v[208:211], v[32:35]
    ds_read_b128 a[4:7], v5 offset:16384
    s_add_u32 s64, s6, 0
    s_and_b32 s64, s64, 15
    s_mul_i32 s64, s64, 36864
    s_add_u32 m0, s9, 0
    s_add_u32 s64, s64, s8
    buffer_load_dwordx4 v232, s[16:19], s64 offen offset:0 lds
    v_mfma_f32_16x16x32_bf16 v[32:35], a[8:11], v[212:215], v[32:35]
    ds_read_b128 a[8:11], v6 offset:16384
    v_mfma_f32_16x16x32_bf16 v[32:35], a[12:15], v[216:219], v[32:35]
    ds_read_b128 a[12:15], v7 offset:16384
    v_mfma_f32_16x16x32_bf16 v[36:39], a[16:19], v[204:207], v[48:51]
    ds_read_b128 a[16:19], v4 offset:20480
    v_cvt_pk_bf16_f32 v58, v28, v29
    v_mfma_f32_16x16x32_bf16 v[36:39], a[20:23], v[208:211], v[36:39]
    ds_read_b128 a[20:23], v5 offset:20480
    v_cvt_pk_bf16_f32 v59, v30, v31
    v_mfma_f32_16x16x32_bf16 v[36:39], a[24:27], v[212:215], v[36:39]
    ds_read_b128 a[24:27], v6 offset:20480
    v_mfma_f32_16x16x32_bf16 v[36:39], a[28:31], v[216:219], v[36:39]
    ds_read_b128 a[28:31], v7 offset:20480
    v_mfma_f32_16x16x32_bf16 v[96:99], a[32:35], v[56:59], v[96:99]
    v_mfma_f32_16x16x32_bf16 v[100:103], a[36:39], v[56:59], v[100:103]
    buffer_load_dwordx4 v233, s[16:19], s64 offen offset:1024 lds
    v_mfma_f32_16x16x32_bf16 v[104:107], a[40:43], v[56:59], v[104:107]
    v_mfma_f32_16x16x32_bf16 v[108:111], a[44:47], v[56:59], v[108:111]
    v_mfma_f32_16x16x32_bf16 v[112:115], a[48:51], v[56:59], v[112:115]
    v_exp_f32 v32, v32
    v_mfma_f32_16x16x32_bf16 v[116:119], a[52:55], v[56:59], v[116:119]
    v_exp_f32 v33, v33
    v_mfma_f32_16x16x32_bf16 v[120:123], a[56:59], v[56:59], v[120:123]
    v_exp_f32 v34, v34
    v_mfma_f32_16x16x32_bf16 v[124:127], a[60:63], v[56:59], v[124:127]
    s_waitcnt lgkmcnt(0)
    v_exp_f32 v35, v35
    v_mfma_f32_16x16x32_bf16 v[164:167], a[64:67], v[56:59], v[164:167]
    v_exp_f32 v36, v36
    v_mfma_f32_16x16x32_bf16 v[16:19], a[0:3], v[172:175], v[40:43]
    buffer_load_dwordx4 v234, s[16:19], s64 offen offset:2048 lds
    v_exp_f32 v37, v37
    v_mfma_f32_16x16x32_bf16 v[16:19], a[4:7], v[176:179], v[16:19]
    v_exp_f32 v38, v38
    v_mfma_f32_16x16x32_bf16 v[16:19], a[8:11], v[180:183], v[16:19]
    v_exp_f32 v39, v39
    v_mfma_f32_16x16x32_bf16 v[16:19], a[12:15], v[184:187], v[16:19]
    v_cvt_pk_bf16_f32 v60, v32, v33
    v_cvt_pk_bf16_f32 v61, v34, v35
    v_mfma_f32_16x16x32_bf16 v[20:23], a[16:19], v[172:175], v[40:43]
    v_cvt_pk_bf16_f32 v62, v36, v37
    v_cvt_pk_bf16_f32 v63, v38, v39
    v_mfma_f32_16x16x32_bf16 v[20:23], a[20:23], v[176:179], v[20:23]
    s_nop 0
    v_mfma_f32_16x16x32_bf16 v[20:23], a[24:27], v[180:183], v[20:23]
    v_exp_f32 v16, v16
    v_mfma_f32_16x16x32_bf16 v[20:23], a[28:31], v[184:187], v[20:23]
    v_exp_f32 v17, v17
    v_mfma_f32_16x16x32_bf16 v[128:131], a[32:35], v[60:63], v[128:131]
    ds_read_b64_tr_b16 a[32:33], v8 offset:16384
    ds_read_b64_tr_b16 a[34:35], v8 offset:20480
    buffer_load_dwordx4 v235, s[16:19], s64 offen offset:3072 lds
    v_mfma_f32_16x16x32_bf16 v[132:135], a[36:39], v[60:63], v[132:135]
    v_exp_f32 v18, v18
    v_mfma_f32_16x16x32_bf16 v[136:139], a[40:43], v[60:63], v[136:139]
    ds_read_b64_tr_b16 a[36:37], v9 offset:16384
    ds_read_b64_tr_b16 a[38:39], v9 offset:20480
    v_mfma_f32_16x16x32_bf16 v[140:143], a[44:47], v[60:63], v[140:143]
    v_exp_f32 v19, v19
    v_mfma_f32_16x16x32_bf16 v[144:147], a[48:51], v[60:63], v[144:147]
    ds_read_b64_tr_b16 a[40:41], v10 offset:16384
    ds_read_b64_tr_b16 a[42:43], v10 offset:20480
    v_mfma_f32_16x16x32_bf16 v[148:151], a[52:55], v[60:63], v[148:151]
    v_exp_f32 v20, v20
    v_mfma_f32_16x16x32_bf16 v[152:155], a[56:59], v[60:63], v[152:155]
    ds_read_b64_tr_b16 a[44:45], v11 offset:16384
    ds_read_b64_tr_b16 a[46:47], v11 offset:20480
    v_mfma_f32_16x16x32_bf16 v[156:159], a[60:63], v[60:63], v[156:159]
    v_exp_f32 v21, v21
    v_mfma_f32_16x16x32_bf16 v[168:171], a[64:67], v[60:63], v[168:171]
    ds_read_b64_tr_b16 a[48:49], v12 offset:16384
    ds_read_b64_tr_b16 a[50:51], v12 offset:20480
    s_add_u32 s64, s6, 1
    s_and_b32 s64, s64, 15
    s_mul_i32 s64, s64, 36864
    s_add_u32 m0, s9, 4096
    s_add_u32 s64, s64, s8
    buffer_load_dwordx4 v232, s[16:19], s64 offen offset:0 lds
    v_mfma_f32_16x16x32_bf16 v[24:27], a[0:3], v[188:191], v[44:47]
    v_exp_f32 v22, v22
    v_mfma_f32_16x16x32_bf16 v[24:27], a[4:7], v[192:195], v[24:27]
    ds_read_b64_tr_b16 a[52:53], v13 offset:16384
    ds_read_b64_tr_b16 a[54:55], v13 offset:20480
    v_mfma_f32_16x16x32_bf16 v[24:27], a[8:11], v[196:199], v[24:27]
    v_exp_f32 v23, v23
    v_mfma_f32_16x16x32_bf16 v[24:27], a[12:15], v[200:203], v[24:27]
    ds_read_b64_tr_b16 a[56:57], v14 offset:16384
    ds_read_b64_tr_b16 a[58:59], v14 offset:20480
    v_mfma_f32_16x16x32_bf16 v[28:31], a[16:19], v[188:191], v[44:47]
    v_cvt_pk_bf16_f32 v52, v16, v17
    v_cvt_pk_bf16_f32 v53, v18, v19
    v_mfma_f32_16x16x32_bf16 v[28:31], a[20:23], v[192:195], v[28:31]
    v_cvt_pk_bf16_f32 v54, v20, v21
    v_cvt_pk_bf16_f32 v55, v22, v23
    v_mfma_f32_16x16x32_bf16 v[28:31], a[24:27], v[196:199], v[28:31]
    ds_read_b64_tr_b16 a[60:61], v15 offset:16384
    ds_read_b64_tr_b16 a[62:63], v15 offset:20480
    v_mfma_f32_16x16x32_bf16 v[28:31], a[28:31], v[200:203], v[28:31]
    s_waitcnt lgkmcnt(4)
    buffer_load_dwordx4 v233, s[16:19], s64 offen offset:1024 lds
    v_exp_f32 v24, v24
    v_mfma_f32_16x16x32_bf16 v[64:67], a[32:35], v[52:55], v[64:67]
    v_exp_f32 v25, v25
    v_mfma_f32_16x16x32_bf16 v[68:71], a[36:39], v[52:55], v[68:71]
    v_exp_f32 v26, v26
    v_mfma_f32_16x16x32_bf16 v[72:75], a[40:43], v[52:55], v[72:75]
    v_exp_f32 v27, v27
    v_mfma_f32_16x16x32_bf16 v[76:79], a[44:47], v[52:55], v[76:79]
    v_exp_f32 v28, v28
    v_mfma_f32_16x16x32_bf16 v[80:83], a[48:51], v[52:55], v[80:83]
    v_exp_f32 v29, v29
    v_mfma_f32_16x16x32_bf16 v[84:87], a[52:55], v[52:55], v[84:87]
    s_waitcnt lgkmcnt(0)
    v_exp_f32 v30, v30
    v_mfma_f32_16x16x32_bf16 v[88:91], a[56:59], v[52:55], v[88:91]
    v_exp_f32 v31, v31
    v_mfma_f32_16x16x32_bf16 v[92:95], a[60:63], v[52:55], v[92:95]
    buffer_load_dwordx4 v234, s[16:19], s64 offen offset:2048 lds
    v_cvt_pk_bf16_f32 v56, v24, v25
    v_cvt_pk_bf16_f32 v57, v26, v27
    v_mfma_f32_16x16x32_bf16 v[160:163], a[64:67], v[52:55], v[160:163]
    s_waitcnt vmcnt(7) lgkmcnt(0)
    s_barrier
    v_mfma_f32_16x16x32_bf16 v[32:35], a[0:3], v[204:207], v[48:51]
    ds_read_b128 a[0:3], v4 offset:24576
    v_mfma_f32_16x16x32_bf16 v[32:35], a[4:7], v[208:211], v[32:35]
    ds_read_b128 a[4:7], v5 offset:24576
    v_mfma_f32_16x16x32_bf16 v[32:35], a[8:11], v[212:215], v[32:35]
    ds_read_b128 a[8:11], v6 offset:24576
    v_mfma_f32_16x16x32_bf16 v[32:35], a[12:15], v[216:219], v[32:35]
    ds_read_b128 a[12:15], v7 offset:24576
    v_mfma_f32_16x16x32_bf16 v[36:39], a[16:19], v[204:207], v[48:51]
    ds_read_b128 a[16:19], v4 offset:28672
    v_cvt_pk_bf16_f32 v58, v28, v29
    v_mfma_f32_16x16x32_bf16 v[36:39], a[20:23], v[208:211], v[36:39]
    ds_read_b128 a[20:23], v5 offset:28672
    v_cvt_pk_bf16_f32 v59, v30, v31
    v_mfma_f32_16x16x32_bf16 v[36:39], a[24:27], v[212:215], v[36:39]
    ds_read_b128 a[24:27], v6 offset:28672
    buffer_load_dwordx4 v235, s[16:19], s64 offen offset:3072 lds
    v_mfma_f32_16x16x32_bf16 v[36:39], a[28:31], v[216:219], v[36:39]
    ds_read_b128 a[28:31], v7 offset:28672
    v_mfma_f32_16x16x32_bf16 v[96:99], a[32:35], v[56:59], v[96:99]
    v_mfma_f32_16x16x32_bf16 v[100:103], a[36:39], v[56:59], v[100:103]
    v_mfma_f32_16x16x32_bf16 v[104:107], a[40:43], v[56:59], v[104:107]
    v_mfma_f32_16x16x32_bf16 v[108:111], a[44:47], v[56:59], v[108:111]
    v_mfma_f32_16x16x32_bf16 v[112:115], a[48:51], v[56:59], v[112:115]
    v_exp_f32 v32, v32
    v_mfma_f32_16x16x32_bf16 v[116:119], a[52:55], v[56:59], v[116:119]
    v_exp_f32 v33, v33
    v_mfma_f32_16x16x32_bf16 v[120:123], a[56:59], v[56:59], v[120:123]
    s_add_u32 s64, s6, 2
    s_and_b32 s64, s64, 15
    s_mul_i32 s64, s64, 36864
    s_add_u32 m0, s9, 8192
    s_add_u32 s64, s64, s8
    buffer_load_dwordx4 v232, s[16:19], s64 offen offset:0 lds
    v_exp_f32 v34, v34
    v_mfma_f32_16x16x32_bf16 v[124:127], a[60:63], v[56:59], v[124:127]
    s_waitcnt lgkmcnt(0)
    v_exp_f32 v35, v35
    v_mfma_f32_16x16x32_bf16 v[164:167], a[64:67], v[56:59], v[164:167]
    v_exp_f32 v36, v36
    v_mfma_f32_16x16x32_bf16 v[16:19], a[0:3], v[172:175], v[40:43]
    v_exp_f32 v37, v37
    v_mfma_f32_16x16x32_bf16 v[16:19], a[4:7], v[176:179], v[16:19]
    v_exp_f32 v38, v38
    v_mfma_f32_16x16x32_bf16 v[16:19], a[8:11], v[180:183], v[16:19]
    v_exp_f32 v39, v39
    v_mfma_f32_16x16x32_bf16 v[16:19], a[12:15], v[184:187], v[16:19]
    v_cvt_pk_bf16_f32 v60, v32, v33
    v_cvt_pk_bf16_f32 v61, v34, v35
    v_mfma_f32_16x16x32_bf16 v[20:23], a[16:19], v[172:175], v[40:43]
    v_cvt_pk_bf16_f32 v62, v36, v37
    v_cvt_pk_bf16_f32 v63, v38, v39
    v_mfma_f32_16x16x32_bf16 v[20:23], a[20:23], v[176:179], v[20:23]
    s_nop 0
    buffer_load_dwordx4 v233, s[16:19], s64 offen offset:1024 lds
    v_mfma_f32_16x16x32_bf16 v[20:23], a[24:27], v[180:183], v[20:23]
    v_exp_f32 v16, v16
    v_mfma_f32_16x16x32_bf16 v[20:23], a[28:31], v[184:187], v[20:23]
    v_exp_f32 v17, v17
    v_mfma_f32_16x16x32_bf16 v[128:131], a[32:35], v[60:63], v[128:131]
    ds_read_b64_tr_b16 a[32:33], v8 offset:24576
    ds_read_b64_tr_b16 a[34:35], v8 offset:28672
    v_mfma_f32_16x16x32_bf16 v[132:135], a[36:39], v[60:63], v[132:135]
    v_exp_f32 v18, v18
    v_mfma_f32_16x16x32_bf16 v[136:139], a[40:43], v[60:63], v[136:139]
    ds_read_b64_tr_b16 a[36:37], v9 offset:24576
    ds_read_b64_tr_b16 a[38:39], v9 offset:28672
    v_mfma_f32_16x16x32_bf16 v[140:143], a[44:47], v[60:63], v[140:143]
    v_exp_f32 v19, v19
    v_mfma_f32_16x16x32_bf16 v[144:147], a[48:51], v[60:63], v[144:147]
    ds_read_b64_tr_b16 a[40:41], v10 offset:24576
    ds_read_b64_tr_b16 a[42:43], v10 offset:28672
    v_mfma_f32_16x16x32_bf16 v[148:151], a[52:55], v[60:63], v[148:151]
    buffer_load_dwordx4 v234, s[16:19], s64 offen offset:2048 lds
    v_exp_f32 v20, v20
    v_mfma_f32_16x16x32_bf16 v[152:155], a[56:59], v[60:63], v[152:155]
    ds_read_b64_tr_b16 a[44:45], v11 offset:24576
    ds_read_b64_tr_b16 a[46:47], v11 offset:28672
    v_mfma_f32_16x16x32_bf16 v[156:159], a[60:63], v[60:63], v[156:159]
    v_exp_f32 v21, v21
    v_mfma_f32_16x16x32_bf16 v[168:171], a[64:67], v[60:63], v[168:171]
    ds_read_b64_tr_b16 a[48:49], v12 offset:24576
    ds_read_b64_tr_b16 a[50:51], v12 offset:28672
    v_mfma_f32_16x16x32_bf16 v[24:27], a[0:3], v[188:191], v[44:47]
    v_exp_f32 v22, v22
    v_mfma_f32_16x16x32_bf16 v[24:27], a[4:7], v[192:195], v[24:27]
    ds_read_b64_tr_b16 a[52:53], v13 offset:24576
    ds_read_b64_tr_b16 a[54:55], v13 offset:28672
    v_mfma_f32_16x16x32_bf16 v[24:27], a[8:11], v[196:199], v[24:27]
    v_exp_f32 v23, v23
    v_mfma_f32_16x16x32_bf16 v[24:27], a[12:15], v[200:203], v[24:27]
    ds_read_b64_tr_b16 a[56:57], v14 offset:24576
    ds_read_b64_tr_b16 a[58:59], v14 offset:28672
    v_mfma_f32_16x16x32_bf16 v[28:31], a[16:19], v[188:191], v[44:47]
    buffer_load_dwordx4 v235, s[16:19], s64 offen offset:3072 lds
    v_cvt_pk_bf16_f32 v52, v16, v17
    v_cvt_pk_bf16_f32 v53, v18, v19
    v_mfma_f32_16x16x32_bf16 v[28:31], a[20:23], v[192:195], v[28:31]
    v_cvt_pk_bf16_f32 v54, v20, v21
    v_cvt_pk_bf16_f32 v55, v22, v23
    v_mfma_f32_16x16x32_bf16 v[28:31], a[24:27], v[196:199], v[28:31]
    ds_read_b64_tr_b16 a[60:61], v15 offset:24576
    ds_read_b64_tr_b16 a[62:63], v15 offset:28672
    v_mfma_f32_16x16x32_bf16 v[28:31], a[28:31], v[200:203], v[28:31]
    s_waitcnt lgkmcnt(4)
    v_exp_f32 v24, v24
    v_mfma_f32_16x16x32_bf16 v[64:67], a[32:35], v[52:55], v[64:67]
    v_exp_f32 v25, v25
    v_mfma_f32_16x16x32_bf16 v[68:71], a[36:39], v[52:55], v[68:71]
    v_exp_f32 v26, v26
    v_mfma_f32_16x16x32_bf16 v[72:75], a[40:43], v[52:55], v[72:75]
    v_exp_f32 v27, v27
    v_mfma_f32_16x16x32_bf16 v[76:79], a[44:47], v[52:55], v[76:79]
    v_exp_f32 v28, v28
    v_mfma_f32_16x16x32_bf16 v[80:83], a[48:51], v[52:55], v[80:83]
    v_exp_f32 v29, v29
    v_mfma_f32_16x16x32_bf16 v[84:87], a[52:55], v[52:55], v[84:87]
    s_waitcnt lgkmcnt(0)
    v_exp_f32 v30, v30
    v_mfma_f32_16x16x32_bf16 v[88:91], a[56:59], v[52:55], v[88:91]
    v_exp_f32 v31, v31
    v_mfma_f32_16x16x32_bf16 v[92:95], a[60:63], v[52:55], v[92:95]
    v_cvt_pk_bf16_f32 v56, v24, v25
    v_cvt_pk_bf16_f32 v57, v26, v27
    v_mfma_f32_16x16x32_bf16 v[160:163], a[64:67], v[52:55], v[160:163]
    s_waitcnt lgkmcnt(0)
    s_barrier
    v_mfma_f32_16x16x32_bf16 v[32:35], a[0:3], v[204:207], v[48:51]
    v_mfma_f32_16x16x32_bf16 v[32:35], a[4:7], v[208:211], v[32:35]
    v_mfma_f32_16x16x32_bf16 v[32:35], a[8:11], v[212:215], v[32:35]
    v_mfma_f32_16x16x32_bf16 v[32:35], a[12:15], v[216:219], v[32:35]
    s_nop 1
    v_rcp_f32 v162, v160
    s_nop 0
    v_mov_b32 v163, v162
    v_mul_f32 v64, v162, v64
    v_mul_f32 v65, v162, v65
    v_mfma_f32_16x16x32_bf16 v[36:39], a[16:19], v[204:207], v[48:51]
    v_cvt_pk_bf16_f32 v58, v28, v29
    v_mul_f32 v66, v162, v66
    v_mul_f32 v67, v162, v67
    v_mul_f32 v68, v162, v68
    v_mul_f32 v69, v162, v69
    v_mfma_f32_16x16x32_bf16 v[36:39], a[20:23], v[208:211], v[36:39]
    v_cvt_pk_bf16_f32 v59, v30, v31
    v_mul_f32 v70, v162, v70
    v_mul_f32 v71, v162, v71
    v_cvt_pk_bf16_f32 v64, v64, v65
    v_mfma_f32_16x16x32_bf16 v[36:39], a[24:27], v[212:215], v[36:39]
    v_cvt_pk_bf16_f32 v65, v66, v67
    v_cvt_pk_bf16_f32 v66, v68, v69
    v_cvt_pk_bf16_f32 v67, v70, v71
    buffer_store_dwordx4 v[64:67], v245, s[48:51], s93 offen offset:0 sc1
    v_mul_f32 v72, v162, v72
    v_mfma_f32_16x16x32_bf16 v[36:39], a[28:31], v[216:219], v[36:39]
    v_mul_f32 v73, v162, v73
    v_mul_f32 v74, v162, v74
    v_mul_f32 v75, v162, v75
    v_mul_f32 v76, v162, v76
    v_mul_f32 v77, v162, v77
    v_mfma_f32_16x16x32_bf16 v[96:99], a[32:35], v[56:59], v[96:99]
    v_mul_f32 v78, v162, v78
    v_mul_f32 v79, v162, v79
    v_cvt_pk_bf16_f32 v72, v72, v73
    v_cvt_pk_bf16_f32 v73, v74, v75
    v_cvt_pk_bf16_f32 v74, v76, v77
    v_mfma_f32_16x16x32_bf16 v[100:103], a[36:39], v[56:59], v[100:103]
    v_cvt_pk_bf16_f32 v75, v78, v79
    buffer_store_dwordx4 v[72:75], v245, s[48:51], s93 offen offset:1024 sc1
    v_mul_f32 v80, v162, v80
    v_mul_f32 v81, v162, v81
    v_mul_f32 v82, v162, v82
    v_mfma_f32_16x16x32_bf16 v[104:107], a[40:43], v[56:59], v[104:107]
    v_mul_f32 v83, v162, v83
    v_mul_f32 v84, v162, v84
    v_mul_f32 v85, v162, v85
    v_mul_f32 v86, v162, v86
    v_mfma_f32_16x16x32_bf16 v[108:111], a[44:47], v[56:59], v[108:111]
    v_mul_f32 v87, v162, v87
    v_cvt_pk_bf16_f32 v80, v80, v81
    v_cvt_pk_bf16_f32 v81, v82, v83
    v_cvt_pk_bf16_f32 v82, v84, v85
    v_cvt_pk_bf16_f32 v83, v86, v87
    v_mfma_f32_16x16x32_bf16 v[112:115], a[48:51], v[56:59], v[112:115]
    v_exp_f32 v32, v32
    buffer_store_dwordx4 v[80:83], v245, s[48:51], s93 offen offset:2048 sc1
    v_mul_f32 v88, v162, v88
    v_mul_f32 v89, v162, v89
    v_mfma_f32_16x16x32_bf16 v[116:119], a[52:55], v[56:59], v[116:119]
    v_exp_f32 v33, v33
    v_mul_f32 v90, v162, v90
    v_mul_f32 v91, v162, v91
    v_mul_f32 v92, v162, v92
    v_mfma_f32_16x16x32_bf16 v[120:123], a[56:59], v[56:59], v[120:123]
    v_exp_f32 v34, v34
    v_mul_f32 v93, v162, v93
    v_mul_f32 v94, v162, v94
    v_mfma_f32_16x16x32_bf16 v[124:127], a[60:63], v[56:59], v[124:127]
    s_waitcnt lgkmcnt(0)
    v_exp_f32 v35, v35
    v_mul_f32 v95, v162, v95
    v_cvt_pk_bf16_f32 v88, v88, v89
    v_cvt_pk_bf16_f32 v89, v90, v91
    v_mfma_f32_16x16x32_bf16 v[164:167], a[64:67], v[56:59], v[164:167]
    v_exp_f32 v36, v36
    v_cvt_pk_bf16_f32 v90, v92, v93
    v_cvt_pk_bf16_f32 v91, v94, v95
    buffer_store_dwordx4 v[88:91], v245, s[48:51], s93 offen offset:3072 sc1
L1_tail:
    v_exp_f32 v37, v37
    v_exp_f32 v38, v38
    v_exp_f32 v39, v39
    v_cvt_pk_bf16_f32 v60, v32, v33
    v_cvt_pk_bf16_f32 v61, v34, v35
    v_cvt_pk_bf16_f32 v62, v36, v37
    v_cvt_pk_bf16_f32 v63, v38, v39
    v_rcp_f32 v166, v164
    s_nop 0
    v_mov_b32 v167, v166
    v_mul_f32 v96, v166, v96
    v_mul_f32 v97, v166, v97
    v_mul_f32 v98, v166, v98
    v_mul_f32 v99, v166, v99
    v_mul_f32 v100, v166, v100
    v_mul_f32 v101, v166, v101
    v_mul_f32 v102, v166, v102
    v_mul_f32 v103, v166, v103
    v_mfma_f32_16x16x32_bf16 v[128:131], a[32:35], v[60:63], v[128:131]
    v_cvt_pk_bf16_f32 v96, v96, v97
    v_cvt_pk_bf16_f32 v97, v98, v99
    v_cvt_pk_bf16_f32 v98, v100, v101
    v_cvt_pk_bf16_f32 v99, v102, v103
    buffer_store_dwordx4 v[96:99], v245, s[48:51], s94 offen offset:0 sc1
    v_mfma_f32_16x16x32_bf16 v[132:135], a[36:39], v[60:63], v[132:135]
    v_mul_f32 v104, v166, v104
    v_mul_f32 v105, v166, v105
    v_mul_f32 v106, v166, v106
    v_mul_f32 v107, v166, v107
    v_mul_f32 v108, v166, v108
    v_mfma_f32_16x16x32_bf16 v[136:139], a[40:43], v[60:63], v[136:139]
    v_mul_f32 v109, v166, v109
    v_mul_f32 v110, v166, v110
    v_mul_f32 v111, v166, v111
    v_cvt_pk_bf16_f32 v104, v104, v105
    v_cvt_pk_bf16_f32 v105, v106, v107
    v_mfma_f32_16x16x32_bf16 v[140:143], a[44:47], v[60:63], v[140:143]
    v_cvt_pk_bf16_f32 v106, v108, v109
    v_cvt_pk_bf16_f32 v107, v110, v111
    buffer_store_dwordx4 v[104:107], v245, s[48:51], s94 offen offset:1024 sc1
    v_mul_f32 v112, v166, v112
    v_mul_f32 v113, v166, v113
    v_mfma_f32_16x16x32_bf16 v[144:147], a[48:51], v[60:63], v[144:147]
    v_mul_f32 v114, v166, v114
    v_mul_f32 v115, v166, v115
    v_mul_f32 v116, v166, v116
    v_mul_f32 v117, v166, v117
    v_mul_f32 v118, v166, v118
    v_mfma_f32_16x16x32_bf16 v[148:151], a[52:55], v[60:63], v[148:151]
    v_mul_f32 v119, v166, v119
    v_cvt_pk_bf16_f32 v112, v112, v113
    v_cvt_pk_bf16_f32 v113, v114, v115
    v_cvt_pk_bf16_f32 v114, v116, v117
    v_cvt_pk_bf16_f32 v115, v118, v119
    v_mfma_f32_16x16x32_bf16 v[152:155], a[56:59], v[60:63], v[152:155]
    buffer_store_dwordx4 v[112:115], v245, s[48:51], s94 offen offset:2048 sc1
    v_mul_f32 v120, v166, v120
    v_mul_f32 v121, v166, v121
    v_mul_f32 v122, v166, v122
    v_mul_f32 v123, v166, v123
    v_mfma_f32_16x16x32_bf16 v[156:159], a[60:63], v[60:63], v[156:159]
    v_mul_f32 v124, v166, v124
    v_mul_f32 v125, v166, v125
    v_mul_f32 v126, v166, v126
    v_mul_f32 v127, v166, v127
    v_cvt_pk_bf16_f32 v120, v120, v121
    v_mfma_f32_16x16x32_bf16 v[168:171], a[64:67], v[60:63], v[168:171]
    v_cvt_pk_bf16_f32 v121, v122, v123
    v_cvt_pk_bf16_f32 v122, v124, v125
    v_cvt_pk_bf16_f32 v123, v126, v127
    buffer_store_dwordx4 v[120:123], v245, s[48:51], s94 offen offset:3072 sc1
    v_add_f32 v241, v160, v164
    s_nop 2
    v_add_f32 v241, v241, v168
    v_cmp_nge_f32 vcc, 0x5d800000, v241
    s_nop 0
    s_cbranch_vccnz L1_slow
    v_rcp_f32 v170, v168
    s_nop 0
    v_mov_b32 v171, v170
    v_pk_mul_f32 v[128:129], v[128:129], v[170:171]
    v_pk_mul_f32 v[130:131], v[130:131], v[170:171]
    v_pk_mul_f32 v[132:133], v[132:133], v[170:171]
    v_pk_mul_f32 v[134:135], v[134:135], v[170:171]
    v_cvt_pk_bf16_f32 v128, v128, v129
    v_cvt_pk_bf16_f32 v129, v130, v131
    v_cvt_pk_bf16_f32 v130, v132, v133
    v_cvt_pk_bf16_f32 v131, v134, v135
    buffer_store_dwordx4 v[128:131], v245, s[48:51], s95 offen offset:0 sc1
    v_pk_mul_f32 v[136:137], v[136:137], v[170:171]
    v_pk_mul_f32 v[138:139], v[138:139], v[170:171]
    v_pk_mul_f32 v[140:141], v[140:141], v[170:171]
    v_pk_mul_f32 v[142:143], v[142:143], v[170:171]
    v_cvt_pk_bf16_f32 v136, v136, v137
    v_cvt_pk_bf16_f32 v137, v138, v139
    v_cvt_pk_bf16_f32 v138, v140, v141
    v_cvt_pk_bf16_f32 v139, v142, v143
    buffer_store_dwordx4 v[136:139], v245, s[48:51], s95 offen offset:1024 sc1
    v_pk_mul_f32 v[144:145], v[144:145], v[170:171]
    v_pk_mul_f32 v[146:147], v[146:147], v[170:171]
    v_pk_mul_f32 v[148:149], v[148:149], v[170:171]
    v_pk_mul_f32 v[150:151], v[150:151], v[170:171]
    v_cvt_pk_bf16_f32 v144, v144, v145
    v_cvt_pk_bf16_f32 v145, v146, v147
    v_cvt_pk_bf16_f32 v146, v148, v149
    v_cvt_pk_bf16_f32 v147, v150, v151
    buffer_store_dwordx4 v[144:147], v245, s[48:51], s95 offen offset:2048 sc1
    v_pk_mul_f32 v[152:153], v[152:153], v[170:171]
    v_pk_mul_f32 v[154:155], v[154:155], v[170:171]
    v_pk_mul_f32 v[156:157], v[156:157], v[170:171]
    v_pk_mul_f32 v[158:159], v[158:159], v[170:171]
    v_cvt_pk_bf16_f32 v152, v152, v153
    v_cvt_pk_bf16_f32 v153, v154, v155
    v_cvt_pk_bf16_f32 v154, v156, v157
    v_cvt_pk_bf16_f32 v155, v158, v159
    buffer_store_dwordx4 v[152:155], v245, s[48:51], s95 offen offset:3072 sc1
    s_waitcnt vmcnt(0)
L1_fin:
    s_barrier
    s_lshl_b32 s31, s55, 3
    s_add_u32 s31, s31, s57
    s_lshl_b32 s31, s31, 4
    s_add_u32 s31, s31, s56
    s_lshl_b32 s31, s31, 7
    v_mov_b32 v250, 1
    s_cmp_lg_u32 s52, 0
    s_cbranch_scc1 L1_pub
    s_mov_b64 exec, 1
    buffer_store_dword v250, off, s[80:83], s31 sc1
    s_mov_b64 exec, -1
L1_pub:
    s_cmp_lg_u32 s7, 0
    s_cbranch_scc1 L1_end
    s_add_u32 s64, s6, 3
    s_and_b32 s64, s64, 15
    s_mul_i32 s64, s64, 36864
    s_add_u32 m0, s9, 12288
    s_add_u32 s64, s64, s8
    buffer_load_dwordx4 v232, s[16:19], s64 offen offset:0 lds
    buffer_load_dwordx4 v233, s[16:19], s64 offen offset:1024 lds
    buffer_load_dwordx4 v234, s[16:19], s64 offen offset:2048 lds
    buffer_load_dwordx4 v235, s[16:19], s64 offen offset:3072 lds
    s_add_u32 s64, s6, 4
    s_and_b32 s64, s64, 15
    s_mul_i32 s64, s64, 36864
    s_add_u32 m0, s9, 16384
    s_add_u32 s64, s64, s8
    buffer_load_dwordx4 v232, s[16:19], s64 offen offset:0 lds
    buffer_load_dwordx4 v233, s[16:19], s64 offen offset:1024 lds
    buffer_load_dwordx4 v234, s[16:19], s64 offen offset:2048 lds
    buffer_load_dwordx4 v235, s[16:19], s64 offen offset:3072 lds
    s_add_u32 s64, s6, 5
    s_and_b32 s64, s64, 15
    s_mul_i32 s64, s64, 36864
    s_add_u32 m0, s9, 20480
    s_add_u32 s64, s64, s8
    buffer_load_dwordx4 v232, s[16:19], s64 offen offset:0 lds
    buffer_load_dwordx4 v233, s[16:19], s64 offen offset:1024 lds
    buffer_load_dwordx4 v234, s[16:19], s64 offen offset:2048 lds
    buffer_load_dwordx4 v235, s[16:19], s64 offen offset:3072 lds
    s_add_u32 s64, s6, 6
    s_and_b32 s64, s64, 15
    s_mul_i32 s64, s64, 36864
    s_add_u32 m0, s10, 0
    s_add_u32 s64, s64, s8
    buffer_load_dwordx4 v232, s[16:19], s64 offen offset:0 lds
    buffer_load_dwordx4 v233, s[16:19], s64 offen offset:1024 lds
    buffer_load_dwordx4 v234, s[16:19], s64 offen offset:2048 lds
    buffer_load_dwordx4 v235, s[16:19], s64 offen offset:3072 lds
    s_add_u32 s64, s6, 7
    s_and_b32 s64, s64, 15
    s_mul_i32 s64, s64, 36864
    s_add_u32 m0, s10, 4096
    s_add_u32 s64, s64, s8
    buffer_load_dwordx4 v232, s[16:19], s64 offen offset:0 lds
    buffer_load_dwordx4 v233, s[16:19], s64 offen offset:1024 lds
    buffer_load_dwordx4 v234, s[16:19], s64 offen offset:2048 lds
    buffer_load_dwordx4 v235, s[16:19], s64 offen offset:3072 lds
    s_add_u32 s64, s6, 8
    s_and_b32 s64, s64, 15
    s_mul_i32 s64, s64, 36864
    s_add_u32 m0, s10, 8192
    s_add_u32 s64, s64, s8
    buffer_load_dwordx4 v232, s[16:19], s64 offen offset:0 lds
    buffer_load_dwordx4 v233, s[16:19], s64 offen offset:1024 lds
    buffer_load_dwordx4 v234, s[16:19], s64 offen offset:2048 lds
    buffer_load_dwordx4 v235, s[16:19], s64 offen offset:3072 lds
    s_add_u32 s64, s6, 9
    s_and_b32 s64, s64, 15
    s_mul_i32 s64, s64, 36864
    s_add_u32 m0, s10, 12288
    s_add_u32 s64, s64, s8
    buffer_load_dwordx4 v232, s[16:19], s64 offen offset:0 lds
    buffer_load_dwordx4 v233, s[16:19], s64 offen offset:1024 lds
    buffer_load_dwordx4 v234, s[16:19], s64 offen offset:2048 lds
    buffer_load_dwordx4 v235, s[16:19], s64 offen offset:3072 lds
    v_cmp_ne_u32 vcc, 0x80, v248
    s_nop 0
    s_cbranch_vccnz L1_cwait
L1_cok:
    s_lshl_b32 s3, s4, 3
    s_mul_i32 s30, s3, 43
    s_lshr_b32 s30, s30, 8
    s_lshl_b32 s3, s55, 3
    s_add_u32 s30, s30, s3
    s_lshl_b32 s30, s30, 1
    s_add_u32 s30, s30, s92
    s_lshl_b32 s30, s30, 2
    s_add_u32 s30, s30, s52
    s_lshl_b32 s30, s30, 8
    v_bfe_u32 v212, v0, 1, 1
    v_lshlrev_b32 v212, 11, v212
    v_and_b32 v213, 1, v0
    v_lshl_add_u32 v212, v213, 7, v212
    s_waitcnt vmcnt(48)
    ds_read_b64_tr_b16 a[0:1], v224 offset:0
    ds_read_b64_tr_b16 a[2:3], v224 offset:2048
    ds_read_b64_tr_b16 a[4:5], v225 offset:0
    ds_read_b64_tr_b16 a[6:7], v225 offset:2048
    ds_read_b64_tr_b16 a[8:9], v226 offset:0
    ds_read_b64_tr_b16 a[10:11], v226 offset:2048
    ds_read_b64_tr_b16 a[12:13], v227 offset:0
    ds_read_b64_tr_b16 a[14:15], v227 offset:2048
    s_waitcnt vmcnt(44)
    ds_read_b64_tr_b16 a[16:17], v224 offset:4096
    ds_read_b64_tr_b16 a[18:19], v224 offset:6144
    ds_read_b64_tr_b16 a[20:21], v225 offset:4096
    ds_read_b64_tr_b16 a[22:23], v225 offset:6144
    ds_read_b64_tr_b16 a[24:25], v226 offset:4096
    ds_read_b64_tr_b16 a[26:27], v226 offset:6144
    ds_read_b64_tr_b16 a[28:29], v227 offset:4096
    ds_read_b64_tr_b16 a[30:31], v227 offset:6144
    s_waitcnt vmcnt(40)
    ds_read_b64_tr_b16 a[32:33], v224 offset:8192
    ds_read_b64_tr_b16 a[34:35], v224 offset:10240
    ds_read_b64_tr_b16 a[36:37], v225 offset:8192
    ds_read_b64_tr_b16 a[38:39], v225 offset:10240
    ds_read_b64_tr_b16 a[40:41], v226 offset:8192
    ds_read_b64_tr_b16 a[42:43], v226 offset:10240
    ds_read_b64_tr_b16 a[44:45], v227 offset:8192
    ds_read_b64_tr_b16 a[46:47], v227 offset:10240
    s_waitcnt vmcnt(24)
    ds_read_b64_tr_b16 a[48:49], v224 offset:12288
    ds_read_b64_tr_b16 a[50:51], v224 offset:14336
    ds_read_b64_tr_b16 a[52:53], v225 offset:12288
    ds_read_b64_tr_b16 a[54:55], v225 offset:14336
    ds_read_b64_tr_b16 a[56:57], v226 offset:12288
    ds_read_b64_tr_b16 a[58:59], v226 offset:14336
    ds_read_b64_tr_b16 a[60:61], v227 offset:12288
    ds_read_b64_tr_b16 a[62:63], v227 offset:14336
    s_waitcnt vmcnt(20)
    ds_read_b64_tr_b16 a[64:65], v224 offset:16384
    ds_read_b64_tr_b16 a[66:67], v224 offset:18432
    ds_read_b64_tr_b16 a[68:69], v225 offset:16384
    ds_read_b64_tr_b16 a[70:71], v225 offset:18432
    ds_read_b64_tr_b16 a[72:73], v226 offset:16384
    ds_read_b64_tr_b16 a[74:75], v226 offset:18432
    ds_read_b64_tr_b16 a[76:77], v227 offset:16384
    ds_read_b64_tr_b16 a[78:79], v227 offset:18432
    s_waitcnt vmcnt(16)
    ds_read_b64_tr_b16 a[80:81], v224 offset:20480
    ds_read_b64_tr_b16 a[82:83], v224 offset:22528
    ds_read_b64_tr_b16 a[84:85], v225 offset:20480
    ds_read_b64_tr_b16 a[86:87], v225 offset:22528
    ds_read_b64_tr_b16 a[88:89], v226 offset:20480
    ds_read_b64_tr_b16 a[90:91], v226 offset:22528
    ds_read_b64_tr_b16 a[92:93], v227 offset:20480
    ds_read_b64_tr_b16 a[94:95], v227 offset:22528
    s_waitcnt lgkmcnt(0)
    buffer_load_dword v213, v212, s[80:83], s30 offen sc1
    s_add_u32 s64, s6, 10
    s_and_b32 s64, s64, 15
    s_mul_i32 s64, s64, 36864
    s_add_u32 m0, s9, 0
    s_add_u32 s64, s64, s8
    buffer_load_dwordx4 v232, s[16:19], s64 offen offset:0 lds
    buffer_load_dwordx4 v233, s[16:19], s64 offen offset:1024 lds
    buffer_load_dwordx4 v234, s[16:19], s64 offen offset:2048 lds
    buffer_load_dwordx4 v235, s[16:19], s64 offen offset:3072 lds
    s_add_u32 s64, s6, 11
    s_and_b32 s64, s64, 15
    s_mul_i32 s64, s64, 36864
    s_add_u32 m0, s9, 4096
    s_add_u32 s64, s64, s8
    buffer_load_dwordx4 v232, s[16:19], s64 offen offset:0 lds
    buffer_load_dwordx4 v233, s[16:19], s64 offen offset:1024 lds
    buffer_load_dwordx4 v234, s[16:19], s64 offen offset:2048 lds
    buffer_load_dwordx4 v235, s[16:19], s64 offen offset:3072 lds
    s_add_u32 s64, s6, 12
    s_and_b32 s64, s64, 15
    s_mul_i32 s64, s64, 36864
    s_add_u32 m0, s9, 8192
    s_add_u32 s64, s64, s8
    buffer_load_dwordx4 v232, s[16:19], s64 offen offset:0 lds
    buffer_load_dwordx4 v233, s[16:19], s64 offen offset:1024 lds
    buffer_load_dwordx4 v234, s[16:19], s64 offen offset:2048 lds
    buffer_load_dwordx4 v235, s[16:19], s64 offen offset:3072 lds
    s_add_u32 s64, s6, 13
    s_and_b32 s64, s64, 15
    s_mul_i32 s64, s64, 36864
    s_add_u32 m0, s9, 12288
    s_add_u32 s64, s64, s8
    buffer_load_dwordx4 v232, s[16:19], s64 offen offset:0 lds
    buffer_load_dwordx4 v233, s[16:19], s64 offen offset:1024 lds
    buffer_load_dwordx4 v234, s[16:19], s64 offen offset:2048 lds
    buffer_load_dwordx4 v235, s[16:19], s64 offen offset:3072 lds
    s_add_u32 s64, s6, 14
    s_and_b32 s64, s64, 15
    s_mul_i32 s64, s64, 36864
    s_add_u32 m0, s9, 16384
    s_add_u32 s64, s64, s8
    buffer_load_dwordx4 v232, s[16:19], s64 offen offset:0 lds
    buffer_load_dwordx4 v233, s[16:19], s64 offen offset:1024 lds
    buffer_load_dwordx4 v234, s[16:19], s64 offen offset:2048 lds
    buffer_load_dwordx4 v235, s[16:19], s64 offen offset:3072 lds
    s_add_u32 s64, s6, 15
    s_and_b32 s64, s64, 15
    s_mul_i32 s64, s64, 36864
    s_add_u32 m0, s9, 20480
    s_add_u32 s64, s64, s8
    buffer_load_dwordx4 v232, s[16:19], s64 offen offset:0 lds
    buffer_load_dwordx4 v233, s[16:19], s64 offen offset:1024 lds
    buffer_load_dwordx4 v234, s[16:19], s64 offen offset:2048 lds
    buffer_load_dwordx4 v235, s[16:19], s64 offen offset:3072 lds
    s_waitcnt vmcnt(37)
    ds_read_b64_tr_b16 a[96:97], v228 offset:0
    ds_read_b64_tr_b16 a[98:99], v228 offset:2048
    ds_read_b64_tr_b16 a[100:101], v229 offset:0
    ds_read_b64_tr_b16 a[102:103], v229 offset:2048
    ds_read_b64_tr_b16 a[104:105], v230 offset:0
    ds_read_b64_tr_b16 a[106:107], v230 offset:2048
    ds_read_b64_tr_b16 a[108:109], v231 offset:0
    ds_read_b64_tr_b16 a[110:111], v231 offset:2048
    s_waitcnt vmcnt(33)
    ds_read_b64_tr_b16 a[112:113], v228 offset:4096
    ds_read_b64_tr_b16 a[114:115], v228 offset:6144
    ds_read_b64_tr_b16 a[116:117], v229 offset:4096
    ds_read_b64_tr_b16 a[118:119], v229 offset:6144
    ds_read_b64_tr_b16 a[120:121], v230 offset:4096
    ds_read_b64_tr_b16 a[122:123], v230 offset:6144
    ds_read_b64_tr_b16 a[124:125], v231 offset:4096
    ds_read_b64_tr_b16 a[126:127], v231 offset:6144
    s_waitcnt vmcnt(29)
    ds_read_b64_tr_b16 a[128:129], v228 offset:8192
    ds_read_b64_tr_b16 a[130:131], v228 offset:10240
    ds_read_b64_tr_b16 a[132:133], v229 offset:8192
    ds_read_b64_tr_b16 a[134:135], v229 offset:10240
    ds_read_b64_tr_b16 a[136:137], v230 offset:8192
    ds_read_b64_tr_b16 a[138:139], v230 offset:10240
    ds_read_b64_tr_b16 a[140:141], v231 offset:8192
    ds_read_b64_tr_b16 a[142:143], v231 offset:10240
    s_waitcnt vmcnt(25)
    ds_read_b64_tr_b16 a[144:145], v228 offset:12288
    ds_read_b64_tr_b16 a[146:147], v228 offset:14336
    ds_read_b64_tr_b16 a[148:149], v229 offset:12288
    ds_read_b64_tr_b16 a[150:151], v229 offset:14336
    ds_read_b64_tr_b16 a[152:153], v230 offset:12288
    ds_read_b64_tr_b16 a[154:155], v230 offset:14336
    ds_read_b64_tr_b16 a[156:157], v231 offset:12288
    ds_read_b64_tr_b16 a[158:159], v231 offset:14336
    s_waitcnt vmcnt(24)
    v_cmp_ne_u32 vcc, 1, v213
    s_nop 0
    s_cbranch_vccz L1_go
L1_pfw:
    buffer_load_dword v213, v212, s[80:83], s30 offen sc1
    s_waitcnt vmcnt(0)
    v_cmp_ne_u32 vcc, 1, v213
    s_nop 0
    s_cbranch_vccnz L1_pfw
L1_go:
    s_add_u32 s11, s6, 0
    s_and_b32 s11, s11, 15
    s_lshl_b32 s11, s11, 10
    s_add_u32 s11, s11, s12
    buffer_load_dwordx4 v[132:135], v236, s[20:23], s11 offen sc1
    buffer_load_dwordx4 v[136:139], v237, s[20:23], s11 offen sc1
    buffer_load_dwordx4 v[140:143], v238, s[20:23], s11 offen sc1
    buffer_load_dwordx4 v[144:147], v239, s[20:23], s11 offen sc1
    s_add_u32 s11, s6, 1
    s_and_b32 s11, s11, 15
    s_lshl_b32 s11, s11, 10
    s_add_u32 s11, s11, s12
    buffer_load_dwordx4 v[148:151], v236, s[20:23], s11 offen sc1
    buffer_load_dwordx4 v[152:155], v237, s[20:23], s11 offen sc1
    buffer_load_dwordx4 v[156:159], v238, s[20:23], s11 offen sc1
    buffer_load_dwordx4 v[160:163], v239, s[20:23], s11 offen sc1
    s_add_u32 s11, s6, 2
    s_and_b32 s11, s11, 15
    s_lshl_b32 s11, s11, 10
    s_add_u32 s11, s11, s12
    buffer_load_dwordx4 v[164:167], v236, s[20:23], s11 offen sc1
    buffer_load_dwordx4 v[168:171], v237, s[20:23], s11 offen sc1
    buffer_load_dwordx4 v[172:175], v238, s[20:23], s11 offen sc1
    buffer_load_dwordx4 v[176:179], v239, s[20:23], s11 offen sc1
    s_lshl_b32 s3, s4, 1
    s_add_u32 s3, s3, s92
    s_mul_i32 s3, s3, 147456
    s_mul_i32 s30, s55, 1152
    s_add_u32 s3, s3, s30
    s_lshl_b32 s30, s5, 7
    s_add_u32 s3, s3, s30
    s_add_u32 s24, s24, s3
    s_addc_u32 s25, s25, 0
    s_mov_b32 s40, s24
    s_and_b32 s41, s25, 0xffff
    s_mov_b32 s42, 1769472
    s_mov_b32 s43, 0x20000
    s_sub_u32 s42, s42, s3
    s_add_u32 s30, s28, 20971520
    s_addc_u32 s31, s29, 0
    s_mov_b32 s44, s30
    s_and_b32 s45, s31, 0xffff
    s_mov_b32 s46, 4194304
    s_mov_b32 s47, 0x20000
    s_lshl_b32 s93, s2, 2
    s_add_u32 s93, s93, s52
    s_lshl_b32 s93, s93, 12
    s_xor_b32 s94, s93, 32768
    s_lshl_b32 s95, s2, 7
    s_add_u32 s95, s95, 0x8000
    s_xor_b32 s96, s95, 256
    s_mov_b32 s14, 0
    v_lshlrev_b32 v241, 4, v0
    v_add_u32 v242, s10, v241
    s_sub_u32 s3, s52, 1
    s_and_b32 s3, s3, 3
    s_lshl_b32 s3, s3, 14
    v_add_u32 v243, s3, v241
    s_sub_u32 s3, s52, 2
    s_and_b32 s3, s3, 3
    s_lshl_b32 s3, s3, 14
    v_add_u32 v244, s3, v241
    s_sub_u32 s3, s52, 3
    s_and_b32 s3, s3, 3
    s_lshl_b32 s3, s3, 14
    v_add_u32 v245, s3, v241
    v_and_b32 v1, 15, v0
    v_lshrrev_b32 v2, 4, v0
    v_mul_u32_u24 v246, 2304, v1
    v_lshl_add_u32 v246, v2, 3, v246
    s_mul_i32 s30, s52, 36864
    s_waitcnt vmcnt(32)
    ds_read_b64_tr_b16 a[160:161], v224 offset:0
    ds_read_b64_tr_b16 a[162:163], v224 offset:2048
    ds_read_b64_tr_b16 a[164:165], v225 offset:0
    ds_read_b64_tr_b16 a[166:167], v225 offset:2048
    ds_read_b64_tr_b16 a[168:169], v226 offset:0
    ds_read_b64_tr_b16 a[170:171], v226 offset:2048
    ds_read_b64_tr_b16 a[172:173], v227 offset:0
    ds_read_b64_tr_b16 a[174:175], v227 offset:2048
    s_waitcnt vmcnt(28)
    ds_read_b64_tr_b16 a[176:177], v224 offset:4096
    ds_read_b64_tr_b16 a[178:179], v224 offset:6144
    ds_read_b64_tr_b16 a[180:181], v225 offset:4096
    ds_read_b64_tr_b16 a[182:183], v225 offset:6144
    ds_read_b64_tr_b16 a[184:185], v226 offset:4096
    ds_read_b64_tr_b16 a[186:187], v226 offset:6144
    ds_read_b64_tr_b16 a[188:189], v227 offset:4096
    ds_read_b64_tr_b16 a[190:191], v227 offset:6144
    s_waitcnt vmcnt(24)
    ds_read_b64_tr_b16 a[192:193], v224 offset:8192
    ds_read_b64_tr_b16 a[194:195], v224 offset:10240
    ds_read_b64_tr_b16 a[196:197], v225 offset:8192
    ds_read_b64_tr_b16 a[198:199], v225 offset:10240
    ds_read_b64_tr_b16 a[200:201], v226 offset:8192
    ds_read_b64_tr_b16 a[202:203], v226 offset:10240
    ds_read_b64_tr_b16 a[204:205], v227 offset:8192
    ds_read_b64_tr_b16 a[206:207], v227 offset:10240
    s_waitcnt vmcnt(20)
    ds_read_b64_tr_b16 a[208:209], v224 offset:12288
    ds_read_b64_tr_b16 a[210:211], v224 offset:14336
    ds_read_b64_tr_b16 a[212:213], v225 offset:12288
    ds_read_b64_tr_b16 a[214:215], v225 offset:14336
    ds_read_b64_tr_b16 a[216:217], v226 offset:12288
    ds_read_b64_tr_b16 a[218:219], v226 offset:14336
    ds_read_b64_tr_b16 a[220:221], v227 offset:12288
    ds_read_b64_tr_b16 a[222:223], v227 offset:14336
    s_waitcnt vmcnt(16)
    ds_read_b64_tr_b16 a[224:225], v224 offset:16384
    ds_read_b64_tr_b16 a[226:227], v224 offset:18432
    ds_read_b64_tr_b16 a[228:229], v225 offset:16384
    ds_read_b64_tr_b16 a[230:231], v225 offset:18432
    ds_read_b64_tr_b16 a[232:233], v226 offset:16384
    ds_read_b64_tr_b16 a[234:235], v226 offset:18432
    ds_read_b64_tr_b16 a[236:237], v227 offset:16384
    ds_read_b64_tr_b16 a[238:239], v227 offset:18432
    s_waitcnt vmcnt(12)
    ds_read_b64_tr_b16 a[240:241], v224 offset:20480
    ds_read_b64_tr_b16 a[242:243], v224 offset:22528
    ds_read_b64_tr_b16 a[244:245], v225 offset:20480
    ds_read_b64_tr_b16 a[246:247], v225 offset:22528
    ds_read_b64_tr_b16 a[248:249], v226 offset:20480
    ds_read_b64_tr_b16 a[250:251], v226 offset:22528
    ds_read_b64_tr_b16 a[252:253], v227 offset:20480
    ds_read_b64_tr_b16 a[254:255], v227 offset:22528
    s_waitcnt vmcnt(8) lgkmcnt(0)
    v_mfma_f32_16x16x32_bf16 v[68:71], a[0:3], v[132:135], 0
    s_add_u32 s11, s6, 3
    s_and_b32 s11, s11, 15
    s_lshl_b32 s11, s11, 10
    s_add_u32 s11, s11, s12
    buffer_load_dwordx4 v[180:183], v236, s[20:23], s11 offen sc1
    v_mfma_f32_16x16x32_bf16 v[84:87], a[0:3], v[136:139], 0
    v_mfma_f32_16x16x32_bf16 v[100:103], a[0:3], v[140:143], 0
    v_mfma_f32_16x16x32_bf16 v[116:119], a[0:3], v[144:147], 0
    v_mfma_f32_16x16x32_bf16 v[72:75], a[4:7], v[132:135], 0
    buffer_load_dwordx4 v[184:187], v237, s[20:23], s11 offen sc1
    v_mfma_f32_16x16x32_bf16 v[88:91], a[4:7], v[136:139], 0
    v_mfma_f32_16x16x32_bf16 v[104:107], a[4:7], v[140:143], 0
    v_mfma_f32_16x16x32_bf16 v[120:123], a[4:7], v[144:147], 0
    v_mfma_f32_16x16x32_bf16 v[76:79], a[8:11], v[132:135], 0
    buffer_load_dwordx4 v[188:191], v238, s[20:23], s11 offen sc1
    v_mfma_f32_16x16x32_bf16 v[92:95], a[8:11], v[136:139], 0
    v_mfma_f32_16x16x32_bf16 v[108:111], a[8:11], v[140:143], 0
    v_mfma_f32_16x16x32_bf16 v[124:127], a[8:11], v[144:147], 0
    v_mfma_f32_16x16x32_bf16 v[80:83], a[12:15], v[132:135], 0
    buffer_load_dwordx4 v[192:195], v239, s[20:23], s11 offen sc1
    v_mfma_f32_16x16x32_bf16 v[96:99], a[12:15], v[136:139], 0
    v_mfma_f32_16x16x32_bf16 v[112:115], a[12:15], v[140:143], 0
    v_mfma_f32_16x16x32_bf16 v[128:131], a[12:15], v[144:147], 0
    s_waitcnt vmcnt(8) lgkmcnt(0)
    v_mfma_f32_16x16x32_bf16 v[68:71], a[16:19], v[148:151], v[68:71]
    s_add_u32 s11, s6, 4
    s_and_b32 s11, s11, 15
    s_lshl_b32 s11, s11, 10
    s_add_u32 s11, s11, s12
    buffer_load_dwordx4 v[132:135], v236, s[20:23], s11 offen sc1
    v_mfma_f32_16x16x32_bf16 v[84:87], a[16:19], v[152:155], v[84:87]
    v_mfma_f32_16x16x32_bf16 v[100:103], a[16:19], v[156:159], v[100:103]
    v_mfma_f32_16x16x32_bf16 v[116:119], a[16:19], v[160:163], v[116:119]
    v_mfma_f32_16x16x32_bf16 v[72:75], a[20:23], v[148:151], v[72:75]
    buffer_load_dwordx4 v[136:139], v237, s[20:23], s11 offen sc1
    v_mfma_f32_16x16x32_bf16 v[88:91], a[20:23], v[152:155], v[88:91]
    v_mfma_f32_16x16x32_bf16 v[104:107], a[20:23], v[156:159], v[104:107]
    v_mfma_f32_16x16x32_bf16 v[120:123], a[20:23], v[160:163], v[120:123]
    v_mfma_f32_16x16x32_bf16 v[76:79], a[24:27], v[148:151], v[76:79]
    buffer_load_dwordx4 v[140:143], v238, s[20:23], s11 offen sc1
    v_mfma_f32_16x16x32_bf16 v[92:95], a[24:27], v[152:155], v[92:95]
    v_mfma_f32_16x16x32_bf16 v[108:111], a[24:27], v[156:159], v[108:111]
    v_mfma_f32_16x16x32_bf16 v[124:127], a[24:27], v[160:163], v[124:127]
    v_mfma_f32_16x16x32_bf16 v[80:83], a[28:31], v[148:151], v[80:83]
    buffer_load_dwordx4 v[144:147], v239, s[20:23], s11 offen sc1
    v_mfma_f32_16x16x32_bf16 v[96:99], a[28:31], v[152:155], v[96:99]
    v_mfma_f32_16x16x32_bf16 v[112:115], a[28:31], v[156:159], v[112:115]
    v_mfma_f32_16x16x32_bf16 v[128:131], a[28:31], v[160:163], v[128:131]
    s_waitcnt vmcnt(8) lgkmcnt(0)
    v_mfma_f32_16x16x32_bf16 v[68:71], a[32:35], v[164:167], v[68:71]
    s_add_u32 s11, s6, 5
    s_and_b32 s11, s11, 15
    s_lshl_b32 s11, s11, 10
    s_add_u32 s11, s11, s12
    buffer_load_dwordx4 v[148:151], v236, s[20:23], s11 offen sc1
    v_mfma_f32_16x16x32_bf16 v[84:87], a[32:35], v[168:171], v[84:87]
    v_mfma_f32_16x16x32_bf16 v[100:103], a[32:35], v[172:175], v[100:103]
    v_mfma_f32_16x16x32_bf16 v[116:119], a[32:35], v[176:179], v[116:119]
    v_mfma_f32_16x16x32_bf16 v[72:75], a[36:39], v[164:167], v[72:75]
    buffer_load_dwordx4 v[152:155], v237, s[20:23], s11 offen sc1
    v_mfma_f32_16x16x32_bf16 v[88:91], a[36:39], v[168:171], v[88:91]
    v_mfma_f32_16x16x32_bf16 v[104:107], a[36:39], v[172:175], v[104:107]
    v_mfma_f32_16x16x32_bf16 v[120:123], a[36:39], v[176:179], v[120:123]
    v_mfma_f32_16x16x32_bf16 v[76:79], a[40:43], v[164:167], v[76:79]
    buffer_load_dwordx4 v[156:159], v238, s[20:23], s11 offen sc1
    v_mfma_f32_16x16x32_bf16 v[92:95], a[40:43], v[168:171], v[92:95]
    v_mfma_f32_16x16x32_bf16 v[108:111], a[40:43], v[172:175], v[108:111]
    v_mfma_f32_16x16x32_bf16 v[124:127], a[40:43], v[176:179], v[124:127]
    v_mfma_f32_16x16x32_bf16 v[80:83], a[44:47], v[164:167], v[80:83]
    buffer_load_dwordx4 v[160:163], v239, s[20:23], s11 offen sc1
    v_mfma_f32_16x16x32_bf16 v[96:99], a[44:47], v[168:171], v[96:99]
    v_mfma_f32_16x16x32_bf16 v[112:115], a[44:47], v[172:175], v[112:115]
    v_mfma_f32_16x16x32_bf16 v[128:131], a[44:47], v[176:179], v[128:131]
    s_waitcnt vmcnt(8) lgkmcnt(0)
    v_mfma_f32_16x16x32_bf16 v[68:71], a[48:51], v[180:183], v[68:71]
    s_add_u32 s11, s6, 6
    s_and_b32 s11, s11, 15
    s_lshl_b32 s11, s11, 10
    s_add_u32 s11, s11, s12
    buffer_load_dwordx4 v[164:167], v236, s[20:23], s11 offen sc1
    v_mfma_f32_16x16x32_bf16 v[84:87], a[48:51], v[184:187], v[84:87]
    v_mfma_f32_16x16x32_bf16 v[100:103], a[48:51], v[188:191], v[100:103]
    v_mfma_f32_16x16x32_bf16 v[116:119], a[48:51], v[192:195], v[116:119]
    v_mfma_f32_16x16x32_bf16 v[72:75], a[52:55], v[180:183], v[72:75]
    buffer_load_dwordx4 v[168:171], v237, s[20:23], s11 offen sc1
    v_mfma_f32_16x16x32_bf16 v[88:91], a[52:55], v[184:187], v[88:91]
    v_mfma_f32_16x16x32_bf16 v[104:107], a[52:55], v[188:191], v[104:107]
    v_mfma_f32_16x16x32_bf16 v[120:123], a[52:55], v[192:195], v[120:123]
    v_mfma_f32_16x16x32_bf16 v[76:79], a[56:59], v[180:183], v[76:79]
    buffer_load_dwordx4 v[172:175], v238, s[20:23], s11 offen sc1
    v_mfma_f32_16x16x32_bf16 v[92:95], a[56:59], v[184:187], v[92:95]
    v_mfma_f32_16x16x32_bf16 v[108:111], a[56:59], v[188:191], v[108:111]
    v_mfma_f32_16x16x32_bf16 v[124:127], a[56:59], v[192:195], v[124:127]
    v_mfma_f32_16x16x32_bf16 v[80:83], a[60:63], v[180:183], v[80:83]
    buffer_load_dwordx4 v[176:179], v239, s[20:23], s11 offen sc1
    v_mfma_f32_16x16x32_bf16 v[96:99], a[60:63], v[184:187], v[96:99]
    v_mfma_f32_16x16x32_bf16 v[112:115], a[60:63], v[188:191], v[112:115]
    v_mfma_f32_16x16x32_bf16 v[128:131], a[60:63], v[192:195], v[128:131]
    s_waitcnt vmcnt(8) lgkmcnt(0)
    v_mfma_f32_16x16x32_bf16 v[68:71], a[64:67], v[132:135], v[68:71]
    s_add_u32 s11, s6, 7
    s_and_b32 s11, s11, 15
    s_lshl_b32 s11, s11, 10
    s_add_u32 s11, s11, s12
    buffer_load_dwordx4 v[180:183], v236, s[20:23], s11 offen sc1
    v_mfma_f32_16x16x32_bf16 v[84:87], a[64:67], v[136:139], v[84:87]
    v_mfma_f32_16x16x32_bf16 v[100:103], a[64:67], v[140:143], v[100:103]
    v_mfma_f32_16x16x32_bf16 v[116:119], a[64:67], v[144:147], v[116:119]
    v_mfma_f32_16x16x32_bf16 v[72:75], a[68:71], v[132:135], v[72:75]
    buffer_load_dwordx4 v[184:187], v237, s[20:23], s11 offen sc1
    v_mfma_f32_16x16x32_bf16 v[88:91], a[68:71], v[136:139], v[88:91]
    v_mfma_f32_16x16x32_bf16 v[104:107], a[68:71], v[140:143], v[104:107]
    v_mfma_f32_16x16x32_bf16 v[120:123], a[68:71], v[144:147], v[120:123]
    v_mfma_f32_16x16x32_bf16 v[76:79], a[72:75], v[132:135], v[76:79]
    buffer_load_dwordx4 v[188:191], v238, s[20:23], s11 offen sc1
    v_mfma_f32_16x16x32_bf16 v[92:95], a[72:75], v[136:139], v[92:95]
    v_mfma_f32_16x16x32_bf16 v[108:111], a[72:75], v[140:143], v[108:111]
    v_mfma_f32_16x16x32_bf16 v[124:127], a[72:75], v[144:147], v[124:127]
    v_mfma_f32_16x16x32_bf16 v[80:83], a[76:79], v[132:135], v[80:83]
    buffer_load_dwordx4 v[192:195], v239, s[20:23], s11 offen sc1
    v_mfma_f32_16x16x32_bf16 v[96:99], a[76:79], v[136:139], v[96:99]
    v_mfma_f32_16x16x32_bf16 v[112:115], a[76:79], v[140:143], v[112:115]
    v_mfma_f32_16x16x32_bf16 v[128:131], a[76:79], v[144:147], v[128:131]
    s_waitcnt vmcnt(8) lgkmcnt(0)
    v_mfma_f32_16x16x32_bf16 v[68:71], a[80:83], v[148:151], v[68:71]
    s_add_u32 s11, s6, 8
    s_and_b32 s11, s11, 15
    s_lshl_b32 s11, s11, 10
    s_add_u32 s11, s11, s12
    buffer_load_dwordx4 v[132:135], v236, s[20:23], s11 offen sc1
    v_mfma_f32_16x16x32_bf16 v[84:87], a[80:83], v[152:155], v[84:87]
    v_mfma_f32_16x16x32_bf16 v[100:103], a[80:83], v[156:159], v[100:103]
    v_mfma_f32_16x16x32_bf16 v[116:119], a[80:83], v[160:163], v[116:119]
    v_mfma_f32_16x16x32_bf16 v[72:75], a[84:87], v[148:151], v[72:75]
    buffer_load_dwordx4 v[136:139], v237, s[20:23], s11 offen sc1
    v_mfma_f32_16x16x32_bf16 v[88:91], a[84:87], v[152:155], v[88:91]
    v_mfma_f32_16x16x32_bf16 v[104:107], a[84:87], v[156:159], v[104:107]
    v_mfma_f32_16x16x32_bf16 v[120:123], a[84:87], v[160:163], v[120:123]
    v_mfma_f32_16x16x32_bf16 v[76:79], a[88:91], v[148:151], v[76:79]
    buffer_load_dwordx4 v[140:143], v238, s[20:23], s11 offen sc1
    v_mfma_f32_16x16x32_bf16 v[92:95], a[88:91], v[152:155], v[92:95]
    v_mfma_f32_16x16x32_bf16 v[108:111], a[88:91], v[156:159], v[108:111]
    v_mfma_f32_16x16x32_bf16 v[124:127], a[88:91], v[160:163], v[124:127]
    v_mfma_f32_16x16x32_bf16 v[80:83], a[92:95], v[148:151], v[80:83]
    buffer_load_dwordx4 v[144:147], v239, s[20:23], s11 offen sc1
    v_mfma_f32_16x16x32_bf16 v[96:99], a[92:95], v[152:155], v[96:99]
    v_mfma_f32_16x16x32_bf16 v[112:115], a[92:95], v[156:159], v[112:115]
    v_mfma_f32_16x16x32_bf16 v[128:131], a[92:95], v[160:163], v[128:131]
    s_waitcnt vmcnt(8) lgkmcnt(0)
    v_mfma_f32_16x16x32_bf16 v[68:71], a[96:99], v[164:167], v[68:71]
    s_add_u32 s11, s6, 9
    s_and_b32 s11, s11, 15
    s_lshl_b32 s11, s11, 10
    s_add_u32 s11, s11, s12
    buffer_load_dwordx4 v[148:151], v236, s[20:23], s11 offen sc1
    v_mfma_f32_16x16x32_bf16 v[84:87], a[96:99], v[168:171], v[84:87]
    v_mfma_f32_16x16x32_bf16 v[100:103], a[96:99], v[172:175], v[100:103]
    v_mfma_f32_16x16x32_bf16 v[116:119], a[96:99], v[176:179], v[116:119]
    v_mfma_f32_16x16x32_bf16 v[72:75], a[100:103], v[164:167], v[72:75]
    buffer_load_dwordx4 v[152:155], v237, s[20:23], s11 offen sc1
    v_mfma_f32_16x16x32_bf16 v[88:91], a[100:103], v[168:171], v[88:91]
    v_mfma_f32_16x16x32_bf16 v[104:107], a[100:103], v[172:175], v[104:107]
    v_mfma_f32_16x16x32_bf16 v[120:123], a[100:103], v[176:179], v[120:123]
    v_mfma_f32_16x16x32_bf16 v[76:79], a[104:107], v[164:167], v[76:79]
    buffer_load_dwordx4 v[156:159], v238, s[20:23], s11 offen sc1
    v_mfma_f32_16x16x32_bf16 v[92:95], a[104:107], v[168:171], v[92:95]
    v_mfma_f32_16x16x32_bf16 v[108:111], a[104:107], v[172:175], v[108:111]
    v_mfma_f32_16x16x32_bf16 v[124:127], a[104:107], v[176:179], v[124:127]
    v_mfma_f32_16x16x32_bf16 v[80:83], a[108:111], v[164:167], v[80:83]
    buffer_load_dwordx4 v[160:163], v239, s[20:23], s11 offen sc1
    v_mfma_f32_16x16x32_bf16 v[96:99], a[108:111], v[168:171], v[96:99]
    v_mfma_f32_16x16x32_bf16 v[112:115], a[108:111], v[172:175], v[112:115]
    v_mfma_f32_16x16x32_bf16 v[128:131], a[108:111], v[176:179], v[128:131]
    s_waitcnt vmcnt(8) lgkmcnt(0)
    v_mfma_f32_16x16x32_bf16 v[68:71], a[112:115], v[180:183], v[68:71]
    s_add_u32 s11, s6, 10
    s_and_b32 s11, s11, 15
    s_lshl_b32 s11, s11, 10
    s_add_u32 s11, s11, s12
    buffer_load_dwordx4 v[164:167], v236, s[20:23], s11 offen sc1
    v_mfma_f32_16x16x32_bf16 v[84:87], a[112:115], v[184:187], v[84:87]
    v_mfma_f32_16x16x32_bf16 v[100:103], a[112:115], v[188:191], v[100:103]
    v_mfma_f32_16x16x32_bf16 v[116:119], a[112:115], v[192:195], v[116:119]
    v_mfma_f32_16x16x32_bf16 v[72:75], a[116:119], v[180:183], v[72:75]
    buffer_load_dwordx4 v[168:171], v237, s[20:23], s11 offen sc1
    v_mfma_f32_16x16x32_bf16 v[88:91], a[116:119], v[184:187], v[88:91]
    v_mfma_f32_16x16x32_bf16 v[104:107], a[116:119], v[188:191], v[104:107]
    v_mfma_f32_16x16x32_bf16 v[120:123], a[116:119], v[192:195], v[120:123]
    v_mfma_f32_16x16x32_bf16 v[76:79], a[120:123], v[180:183], v[76:79]
    buffer_load_dwordx4 v[172:175], v238, s[20:23], s11 offen sc1
    v_mfma_f32_16x16x32_bf16 v[92:95], a[120:123], v[184:187], v[92:95]
    v_mfma_f32_16x16x32_bf16 v[108:111], a[120:123], v[188:191], v[108:111]
    v_mfma_f32_16x16x32_bf16 v[124:127], a[120:123], v[192:195], v[124:127]
    v_mfma_f32_16x16x32_bf16 v[80:83], a[124:127], v[180:183], v[80:83]
    buffer_load_dwordx4 v[176:179], v239, s[20:23], s11 offen sc1
    v_mfma_f32_16x16x32_bf16 v[96:99], a[124:127], v[184:187], v[96:99]
    v_mfma_f32_16x16x32_bf16 v[112:115], a[124:127], v[188:191], v[112:115]
    v_mfma_f32_16x16x32_bf16 v[128:131], a[124:127], v[192:195], v[128:131]
    s_waitcnt vmcnt(8) lgkmcnt(0)
    v_mfma_f32_16x16x32_bf16 v[68:71], a[128:131], v[132:135], v[68:71]
    s_add_u32 s11, s6, 11
    s_and_b32 s11, s11, 15
    s_lshl_b32 s11, s11, 10
    s_add_u32 s11, s11, s12
    buffer_load_dwordx4 v[180:183], v236, s[20:23], s11 offen sc1
    v_mfma_f32_16x16x32_bf16 v[84:87], a[128:131], v[136:139], v[84:87]
    v_mfma_f32_16x16x32_bf16 v[100:103], a[128:131], v[140:143], v[100:103]
    v_mfma_f32_16x16x32_bf16 v[116:119], a[128:131], v[144:147], v[116:119]
    v_mfma_f32_16x16x32_bf16 v[72:75], a[132:135], v[132:135], v[72:75]
    buffer_load_dwordx4 v[184:187], v237, s[20:23], s11 offen sc1
    v_mfma_f32_16x16x32_bf16 v[88:91], a[132:135], v[136:139], v[88:91]
    v_mfma_f32_16x16x32_bf16 v[104:107], a[132:135], v[140:143], v[104:107]
    v_mfma_f32_16x16x32_bf16 v[120:123], a[132:135], v[144:147], v[120:123]
    v_mfma_f32_16x16x32_bf16 v[76:79], a[136:139], v[132:135], v[76:79]
    buffer_load_dwordx4 v[188:191], v238, s[20:23], s11 offen sc1
    v_mfma_f32_16x16x32_bf16 v[92:95], a[136:139], v[136:139], v[92:95]
    v_mfma_f32_16x16x32_bf16 v[108:111], a[136:139], v[140:143], v[108:111]
    v_mfma_f32_16x16x32_bf16 v[124:127], a[136:139], v[144:147], v[124:127]
    v_mfma_f32_16x16x32_bf16 v[80:83], a[140:143], v[132:135], v[80:83]
    buffer_load_dwordx4 v[192:195], v239, s[20:23], s11 offen sc1
    v_mfma_f32_16x16x32_bf16 v[96:99], a[140:143], v[136:139], v[96:99]
    v_mfma_f32_16x16x32_bf16 v[112:115], a[140:143], v[140:143], v[112:115]
    v_mfma_f32_16x16x32_bf16 v[128:131], a[140:143], v[144:147], v[128:131]
    s_waitcnt vmcnt(8) lgkmcnt(0)
    v_mfma_f32_16x16x32_bf16 v[68:71], a[144:147], v[148:151], v[68:71]
    s_add_u32 s11, s6, 12
    s_and_b32 s11, s11, 15
    s_lshl_b32 s11, s11, 10
    s_add_u32 s11, s11, s12
    buffer_load_dwordx4 v[132:135], v236, s[20:23], s11 offen sc1
    v_mfma_f32_16x16x32_bf16 v[84:87], a[144:147], v[152:155], v[84:87]
    v_mfma_f32_16x16x32_bf16 v[100:103], a[144:147], v[156:159], v[100:103]
    v_mfma_f32_16x16x32_bf16 v[116:119], a[144:147], v[160:163], v[116:119]
    v_mfma_f32_16x16x32_bf16 v[72:75], a[148:151], v[148:151], v[72:75]
    buffer_load_dwordx4 v[136:139], v237, s[20:23], s11 offen sc1
    v_mfma_f32_16x16x32_bf16 v[88:91], a[148:151], v[152:155], v[88:91]
    v_mfma_f32_16x16x32_bf16 v[104:107], a[148:151], v[156:159], v[104:107]
    v_mfma_f32_16x16x32_bf16 v[120:123], a[148:151], v[160:163], v[120:123]
    v_mfma_f32_16x16x32_bf16 v[76:79], a[152:155], v[148:151], v[76:79]
    buffer_load_dwordx4 v[140:143], v238, s[20:23], s11 offen sc1
    v_mfma_f32_16x16x32_bf16 v[92:95], a[152:155], v[152:155], v[92:95]
    v_mfma_f32_16x16x32_bf16 v[108:111], a[152:155], v[156:159], v[108:111]
    v_mfma_f32_16x16x32_bf16 v[124:127], a[152:155], v[160:163], v[124:127]
    v_mfma_f32_16x16x32_bf16 v[80:83], a[156:159], v[148:151], v[80:83]
    buffer_load_dwordx4 v[144:147], v239, s[20:23], s11 offen sc1
    v_mfma_f32_16x16x32_bf16 v[96:99], a[156:159], v[152:155], v[96:99]
    v_mfma_f32_16x16x32_bf16 v[112:115], a[156:159], v[156:159], v[112:115]
    v_mfma_f32_16x16x32_bf16 v[128:131], a[156:159], v[160:163], v[128:131]
    s_waitcnt vmcnt(8) lgkmcnt(0)
    v_mfma_f32_16x16x32_bf16 v[68:71], a[160:163], v[164:167], v[68:71]
    s_add_u32 s11, s6, 13
    s_and_b32 s11, s11, 15
    s_lshl_b32 s11, s11, 10
    s_add_u32 s11, s11, s12
    buffer_load_dwordx4 v[148:151], v236, s[20:23], s11 offen sc1
    v_mfma_f32_16x16x32_bf16 v[84:87], a[160:163], v[168:171], v[84:87]
    v_mfma_f32_16x16x32_bf16 v[100:103], a[160:163], v[172:175], v[100:103]
    v_mfma_f32_16x16x32_bf16 v[116:119], a[160:163], v[176:179], v[116:119]
    v_mfma_f32_16x16x32_bf16 v[72:75], a[164:167], v[164:167], v[72:75]
    buffer_load_dwordx4 v[152:155], v237, s[20:23], s11 offen sc1
    v_mfma_f32_16x16x32_bf16 v[88:91], a[164:167], v[168:171], v[88:91]
    v_mfma_f32_16x16x32_bf16 v[104:107], a[164:167], v[172:175], v[104:107]
    v_mfma_f32_16x16x32_bf16 v[120:123], a[164:167], v[176:179], v[120:123]
    v_mfma_f32_16x16x32_bf16 v[76:79], a[168:171], v[164:167], v[76:79]
    buffer_load_dwordx4 v[156:159], v238, s[20:23], s11 offen sc1
    v_mfma_f32_16x16x32_bf16 v[92:95], a[168:171], v[168:171], v[92:95]
    v_mfma_f32_16x16x32_bf16 v[108:111], a[168:171], v[172:175], v[108:111]
    v_mfma_f32_16x16x32_bf16 v[124:127], a[168:171], v[176:179], v[124:127]
    v_mfma_f32_16x16x32_bf16 v[80:83], a[172:175], v[164:167], v[80:83]
    buffer_load_dwordx4 v[160:163], v239, s[20:23], s11 offen sc1
    v_mfma_f32_16x16x32_bf16 v[96:99], a[172:175], v[168:171], v[96:99]
    v_mfma_f32_16x16x32_bf16 v[112:115], a[172:175], v[172:175], v[112:115]
    v_mfma_f32_16x16x32_bf16 v[128:131], a[172:175], v[176:179], v[128:131]
    s_waitcnt vmcnt(8) lgkmcnt(0)
    v_mfma_f32_16x16x32_bf16 v[68:71], a[176:179], v[180:183], v[68:71]
    s_add_u32 s11, s6, 14
    s_and_b32 s11, s11, 15
    s_lshl_b32 s11, s11, 10
    s_add_u32 s11, s11, s12
    buffer_load_dwordx4 v[164:167], v236, s[20:23], s11 offen sc1
    v_mfma_f32_16x16x32_bf16 v[84:87], a[176:179], v[184:187], v[84:87]
    v_mfma_f32_16x16x32_bf16 v[100:103], a[176:179], v[188:191], v[100:103]
    v_mfma_f32_16x16x32_bf16 v[116:119], a[176:179], v[192:195], v[116:119]
    v_mfma_f32_16x16x32_bf16 v[72:75], a[180:183], v[180:183], v[72:75]
    buffer_load_dwordx4 v[168:171], v237, s[20:23], s11 offen sc1
    v_mfma_f32_16x16x32_bf16 v[88:91], a[180:183], v[184:187], v[88:91]
    v_mfma_f32_16x16x32_bf16 v[104:107], a[180:183], v[188:191], v[104:107]
    v_mfma_f32_16x16x32_bf16 v[120:123], a[180:183], v[192:195], v[120:123]
    v_mfma_f32_16x16x32_bf16 v[76:79], a[184:187], v[180:183], v[76:79]
    buffer_load_dwordx4 v[172:175], v238, s[20:23], s11 offen sc1
    v_mfma_f32_16x16x32_bf16 v[92:95], a[184:187], v[184:187], v[92:95]
    v_mfma_f32_16x16x32_bf16 v[108:111], a[184:187], v[188:191], v[108:111]
    v_mfma_f32_16x16x32_bf16 v[124:127], a[184:187], v[192:195], v[124:127]
    v_mfma_f32_16x16x32_bf16 v[80:83], a[188:191], v[180:183], v[80:83]
    buffer_load_dwordx4 v[176:179], v239, s[20:23], s11 offen sc1
    v_mfma_f32_16x16x32_bf16 v[96:99], a[188:191], v[184:187], v[96:99]
    v_mfma_f32_16x16x32_bf16 v[112:115], a[188:191], v[188:191], v[112:115]
    v_mfma_f32_16x16x32_bf16 v[128:131], a[188:191], v[192:195], v[128:131]
    s_waitcnt vmcnt(8) lgkmcnt(0)
    v_mfma_f32_16x16x32_bf16 v[68:71], a[192:195], v[132:135], v[68:71]
    s_add_u32 s11, s6, 15
    s_and_b32 s11, s11, 15
    s_lshl_b32 s11, s11, 10
    s_add_u32 s11, s11, s12
    buffer_load_dwordx4 v[180:183], v236, s[20:23], s11 offen sc1
    v_mfma_f32_16x16x32_bf16 v[84:87], a[192:195], v[136:139], v[84:87]
    v_mfma_f32_16x16x32_bf16 v[100:103], a[192:195], v[140:143], v[100:103]
    v_mfma_f32_16x16x32_bf16 v[116:119], a[192:195], v[144:147], v[116:119]
    v_mfma_f32_16x16x32_bf16 v[72:75], a[196:199], v[132:135], v[72:75]
    buffer_load_dwordx4 v[184:187], v237, s[20:23], s11 offen sc1
    v_mfma_f32_16x16x32_bf16 v[88:91], a[196:199], v[136:139], v[88:91]
    v_mfma_f32_16x16x32_bf16 v[104:107], a[196:199], v[140:143], v[104:107]
    v_mfma_f32_16x16x32_bf16 v[120:123], a[196:199], v[144:147], v[120:123]
    v_mfma_f32_16x16x32_bf16 v[76:79], a[200:203], v[132:135], v[76:79]
    buffer_load_dwordx4 v[188:191], v238, s[20:23], s11 offen sc1
    v_mfma_f32_16x16x32_bf16 v[92:95], a[200:203], v[136:139], v[92:95]
    v_mfma_f32_16x16x32_bf16 v[108:111], a[200:203], v[140:143], v[108:111]
    v_mfma_f32_16x16x32_bf16 v[124:127], a[200:203], v[144:147], v[124:127]
    v_mfma_f32_16x16x32_bf16 v[80:83], a[204:207], v[132:135], v[80:83]
    buffer_load_dwordx4 v[192:195], v239, s[20:23], s11 offen sc1
    v_mfma_f32_16x16x32_bf16 v[96:99], a[204:207], v[136:139], v[96:99]
    v_mfma_f32_16x16x32_bf16 v[112:115], a[204:207], v[140:143], v[112:115]
    v_mfma_f32_16x16x32_bf16 v[128:131], a[204:207], v[144:147], v[128:131]
    s_waitcnt vmcnt(8) lgkmcnt(0)
    v_mfma_f32_16x16x32_bf16 v[68:71], a[208:211], v[148:151], v[68:71]
    s_add_u32 s11, s6, 0
    s_and_b32 s11, s11, 15
    s_lshl_b32 s11, s11, 10
    s_add_u32 s11, s11, s13
    buffer_load_dwordx4 v[132:135], v236, s[20:23], s11 offen sc1
    v_mfma_f32_16x16x32_bf16 v[84:87], a[208:211], v[152:155], v[84:87]
    v_mfma_f32_16x16x32_bf16 v[100:103], a[208:211], v[156:159], v[100:103]
    v_mfma_f32_16x16x32_bf16 v[116:119], a[208:211], v[160:163], v[116:119]
    v_mfma_f32_16x16x32_bf16 v[72:75], a[212:215], v[148:151], v[72:75]
    buffer_load_dwordx4 v[136:139], v237, s[20:23], s11 offen sc1
    v_mfma_f32_16x16x32_bf16 v[88:91], a[212:215], v[152:155], v[88:91]
    v_mfma_f32_16x16x32_bf16 v[104:107], a[212:215], v[156:159], v[104:107]
    v_mfma_f32_16x16x32_bf16 v[120:123], a[212:215], v[160:163], v[120:123]
    v_mfma_f32_16x16x32_bf16 v[76:79], a[216:219], v[148:151], v[76:79]
    buffer_load_dwordx4 v[140:143], v238, s[20:23], s11 offen sc1
    v_mfma_f32_16x16x32_bf16 v[92:95], a[216:219], v[152:155], v[92:95]
    v_mfma_f32_16x16x32_bf16 v[108:111], a[216:219], v[156:159], v[108:111]
    v_mfma_f32_16x16x32_bf16 v[124:127], a[216:219], v[160:163], v[124:127]
    v_mfma_f32_16x16x32_bf16 v[80:83], a[220:223], v[148:151], v[80:83]
    buffer_load_dwordx4 v[144:147], v239, s[20:23], s11 offen sc1
    v_mfma_f32_16x16x32_bf16 v[96:99], a[220:223], v[152:155], v[96:99]
    v_mfma_f32_16x16x32_bf16 v[112:115], a[220:223], v[156:159], v[112:115]
    v_mfma_f32_16x16x32_bf16 v[128:131], a[220:223], v[160:163], v[128:131]
    s_waitcnt vmcnt(8) lgkmcnt(0)
    v_mfma_f32_16x16x32_bf16 v[68:71], a[224:227], v[164:167], v[68:71]
    s_add_u32 s11, s6, 1
    s_and_b32 s11, s11, 15
    s_lshl_b32 s11, s11, 10
    s_add_u32 s11, s11, s13
    buffer_load_dwordx4 v[148:151], v236, s[20:23], s11 offen sc1
    v_mfma_f32_16x16x32_bf16 v[84:87], a[224:227], v[168:171], v[84:87]
    v_mfma_f32_16x16x32_bf16 v[100:103], a[224:227], v[172:175], v[100:103]
    v_mfma_f32_16x16x32_bf16 v[116:119], a[224:227], v[176:179], v[116:119]
    v_mfma_f32_16x16x32_bf16 v[72:75], a[228:231], v[164:167], v[72:75]
    buffer_load_dwordx4 v[152:155], v237, s[20:23], s11 offen sc1
    v_mfma_f32_16x16x32_bf16 v[88:91], a[228:231], v[168:171], v[88:91]
    v_mfma_f32_16x16x32_bf16 v[104:107], a[228:231], v[172:175], v[104:107]
    v_mfma_f32_16x16x32_bf16 v[120:123], a[228:231], v[176:179], v[120:123]
    v_mfma_f32_16x16x32_bf16 v[76:79], a[232:235], v[164:167], v[76:79]
    buffer_load_dwordx4 v[156:159], v238, s[20:23], s11 offen sc1
    v_mfma_f32_16x16x32_bf16 v[92:95], a[232:235], v[168:171], v[92:95]
    v_mfma_f32_16x16x32_bf16 v[108:111], a[232:235], v[172:175], v[108:111]
    v_mfma_f32_16x16x32_bf16 v[124:127], a[232:235], v[176:179], v[124:127]
    v_mfma_f32_16x16x32_bf16 v[80:83], a[236:239], v[164:167], v[80:83]
    buffer_load_dwordx4 v[160:163], v239, s[20:23], s11 offen sc1
    v_mfma_f32_16x16x32_bf16 v[96:99], a[236:239], v[168:171], v[96:99]
    v_mfma_f32_16x16x32_bf16 v[112:115], a[236:239], v[172:175], v[112:115]
    v_mfma_f32_16x16x32_bf16 v[128:131], a[236:239], v[176:179], v[128:131]
    s_waitcnt vmcnt(8) lgkmcnt(0)
    v_mfma_f32_16x16x32_bf16 v[84:87], a[240:243], v[184:187], v[84:87]
    s_add_u32 s11, s6, 2
    s_and_b32 s11, s11, 15
    s_lshl_b32 s11, s11, 10
    s_add_u32 s11, s11, s13
    buffer_load_dwordx4 v[164:167], v236, s[20:23], s11 offen sc1
    v_mfma_f32_16x16x32_bf16 v[88:91], a[244:247], v[184:187], v[88:91]
    v_mfma_f32_16x16x32_bf16 v[92:95], a[248:251], v[184:187], v[92:95]
    v_mfma_f32_16x16x32_bf16 v[96:99], a[252:255], v[184:187], v[96:99]
    v_mfma_f32_16x16x32_bf16 v[100:103], a[240:243], v[188:191], v[100:103]
    buffer_load_dwordx4 v[168:171], v237, s[20:23], s11 offen sc1
    v_mfma_f32_16x16x32_bf16 v[104:107], a[244:247], v[188:191], v[104:107]
    v_mfma_f32_16x16x32_bf16 v[108:111], a[248:251], v[188:191], v[108:111]
    v_mfma_f32_16x16x32_bf16 v[112:115], a[252:255], v[188:191], v[112:115]
    v_mfma_f32_16x16x32_bf16 v[116:119], a[240:243], v[192:195], v[116:119]
    buffer_load_dwordx4 v[172:175], v238, s[20:23], s11 offen sc1
    v_mfma_f32_16x16x32_bf16 v[120:123], a[244:247], v[192:195], v[120:123]
    v_mfma_f32_16x16x32_bf16 v[124:127], a[248:251], v[192:195], v[124:127]
    v_mfma_f32_16x16x32_bf16 v[128:131], a[252:255], v[192:195], v[128:131]
    v_mfma_f32_16x16x32_bf16 v[68:71], a[240:243], v[180:183], v[68:71]
    buffer_load_dwordx4 v[176:179], v239, s[20:23], s11 offen sc1
    v_mfma_f32_16x16x32_bf16 v[72:75], a[244:247], v[180:183], v[72:75]
    v_mfma_f32_16x16x32_bf16 v[76:79], a[248:251], v[180:183], v[76:79]
    v_mfma_f32_16x16x32_bf16 v[80:83], a[252:255], v[180:183], v[80:83]
    s_waitcnt vmcnt(8) lgkmcnt(0)
    v_mfma_f32_16x16x32_bf16 v[4:7], a[0:3], v[132:135], 0
    s_add_u32 s11, s6, 3
    s_and_b32 s11, s11, 15
    s_lshl_b32 s11, s11, 10
    s_add_u32 s11, s11, s13
    buffer_load_dwordx4 v[180:183], v236, s[20:23], s11 offen sc1
    v_mfma_f32_16x16x32_bf16 v[20:23], a[0:3], v[136:139], 0
    v_mfma_f32_16x16x32_bf16 v[36:39], a[0:3], v[140:143], 0
    ds_write_b128 v242, v[84:87] offset:0
    v_mfma_f32_16x16x32_bf16 v[52:55], a[0:3], v[144:147], 0
    ds_write_b128 v242, v[88:91] offset:1024
    v_mfma_f32_16x16x32_bf16 v[8:11], a[4:7], v[132:135], 0
    buffer_load_dwordx4 v[184:187], v237, s[20:23], s11 offen sc1
    ds_write_b128 v242, v[92:95] offset:2048
    v_mfma_f32_16x16x32_bf16 v[24:27], a[4:7], v[136:139], 0
    ds_write_b128 v242, v[96:99] offset:3072
    v_mfma_f32_16x16x32_bf16 v[40:43], a[4:7], v[140:143], 0
    ds_write_b128 v242, v[100:103] offset:4096
    v_mfma_f32_16x16x32_bf16 v[56:59], a[4:7], v[144:147], 0
    ds_write_b128 v242, v[104:107] offset:5120
    v_mfma_f32_16x16x32_bf16 v[12:15], a[8:11], v[132:135], 0
    buffer_load_dwordx4 v[188:191], v238, s[20:23], s11 offen sc1
    ds_write_b128 v242, v[108:111] offset:6144
    v_mfma_f32_16x16x32_bf16 v[28:31], a[8:11], v[136:139], 0
    ds_write_b128 v242, v[112:115] offset:7168
    v_mfma_f32_16x16x32_bf16 v[44:47], a[8:11], v[140:143], 0
    ds_write_b128 v242, v[116:119] offset:8192
    v_mfma_f32_16x16x32_bf16 v[60:63], a[8:11], v[144:147], 0
    ds_write_b128 v242, v[120:123] offset:9216
    v_mfma_f32_16x16x32_bf16 v[16:19], a[12:15], v[132:135], 0
    buffer_load_dwordx4 v[192:195], v239, s[20:23], s11 offen sc1
    ds_write_b128 v242, v[124:127] offset:10240
    v_mfma_f32_16x16x32_bf16 v[32:35], a[12:15], v[136:139], 0
    ds_write_b128 v242, v[128:131] offset:11264
    v_mfma_f32_16x16x32_bf16 v[48:51], a[12:15], v[140:143], 0
    v_mfma_f32_16x16x32_bf16 v[64:67], a[12:15], v[144:147], 0
    s_waitcnt vmcnt(8) lgkmcnt(0)
    s_barrier
    v_mfma_f32_16x16x32_bf16 v[4:7], a[16:19], v[148:151], v[4:7]
    s_add_u32 s11, s6, 4
    s_and_b32 s11, s11, 15
    s_lshl_b32 s11, s11, 10
    s_add_u32 s11, s11, s13
    buffer_load_dwordx4 v[132:135], v236, s[20:23], s11 offen sc1
    ds_read_b128 v[84:87], v243 offset:0
    v_mfma_f32_16x16x32_bf16 v[20:23], a[16:19], v[152:155], v[20:23]
    ds_read_b128 v[100:103], v244 offset:4096
    v_mfma_f32_16x16x32_bf16 v[36:39], a[16:19], v[156:159], v[36:39]
    ds_read_b128 v[116:119], v245 offset:8192
    v_mfma_f32_16x16x32_bf16 v[52:55], a[16:19], v[160:163], v[52:55]
    ds_read_b128 v[88:91], v243 offset:1024
    v_mfma_f32_16x16x32_bf16 v[8:11], a[20:23], v[148:151], v[8:11]
    buffer_load_dwordx4 v[136:139], v237, s[20:23], s11 offen sc1
    ds_read_b128 v[104:107], v244 offset:5120
    v_mfma_f32_16x16x32_bf16 v[24:27], a[20:23], v[152:155], v[24:27]
    ds_read_b128 v[120:123], v245 offset:9216
    v_mfma_f32_16x16x32_bf16 v[40:43], a[20:23], v[156:159], v[40:43]
    ds_read_b128 v[92:95], v243 offset:2048
    v_mfma_f32_16x16x32_bf16 v[56:59], a[20:23], v[160:163], v[56:59]
    ds_read_b128 v[108:111], v244 offset:6144
    v_mfma_f32_16x16x32_bf16 v[12:15], a[24:27], v[148:151], v[12:15]
    buffer_load_dwordx4 v[140:143], v238, s[20:23], s11 offen sc1
    ds_read_b128 v[124:127], v245 offset:10240
    v_mfma_f32_16x16x32_bf16 v[28:31], a[24:27], v[152:155], v[28:31]
    ds_read_b128 v[96:99], v243 offset:3072
    v_mfma_f32_16x16x32_bf16 v[44:47], a[24:27], v[156:159], v[44:47]
    ds_read_b128 v[112:115], v244 offset:7168
    v_mfma_f32_16x16x32_bf16 v[60:63], a[24:27], v[160:163], v[60:63]
    ds_read_b128 v[128:131], v245 offset:11264
    v_mfma_f32_16x16x32_bf16 v[16:19], a[28:31], v[148:151], v[16:19]
    buffer_load_dwordx4 v[144:147], v239, s[20:23], s11 offen sc1
    v_mfma_f32_16x16x32_bf16 v[32:35], a[28:31], v[152:155], v[32:35]
    v_mfma_f32_16x16x32_bf16 v[48:51], a[28:31], v[156:159], v[48:51]
    v_mfma_f32_16x16x32_bf16 v[64:67], a[28:31], v[160:163], v[64:67]
    s_waitcnt vmcnt(8) lgkmcnt(0)
    v_mfma_f32_16x16x32_bf16 v[4:7], a[32:35], v[164:167], v[4:7]
    s_add_u32 s11, s6, 5
    s_and_b32 s11, s11, 15
    s_lshl_b32 s11, s11, 10
    s_add_u32 s11, s11, s13
    buffer_load_dwordx4 v[148:151], v236, s[20:23], s11 offen sc1
    v_add_f32 v68, v68, v84
    v_mfma_f32_16x16x32_bf16 v[20:23], a[32:35], v[168:171], v[20:23]
    v_add_f32 v69, v69, v85
    v_add_f32 v70, v70, v86
    v_mfma_f32_16x16x32_bf16 v[36:39], a[32:35], v[172:175], v[36:39]
    v_add_f32 v71, v71, v87
    v_add_f32 v68, v68, v100
    v_mfma_f32_16x16x32_bf16 v[52:55], a[32:35], v[176:179], v[52:55]
    v_add_f32 v69, v69, v101
    v_add_f32 v70, v70, v102
    v_mfma_f32_16x16x32_bf16 v[8:11], a[36:39], v[164:167], v[8:11]
    buffer_load_dwordx4 v[152:155], v237, s[20:23], s11 offen sc1
    v_mfma_f32_16x16x32_bf16 v[24:27], a[36:39], v[168:171], v[24:27]
    v_add_f32 v71, v71, v103
    v_add_f32 v68, v68, v116
    v_mfma_f32_16x16x32_bf16 v[40:43], a[36:39], v[172:175], v[40:43]
    v_add_f32 v69, v69, v117
    v_add_f32 v70, v70, v118
    v_mfma_f32_16x16x32_bf16 v[56:59], a[36:39], v[176:179], v[56:59]
    v_add_f32 v71, v71, v119
    buffer_store_dwordx4 v[68:71], v241, s[44:47], s93 offen offset:0 sc1
    v_mfma_f32_16x16x32_bf16 v[12:15], a[40:43], v[164:167], v[12:15]
    buffer_load_dwordx4 v[156:159], v238, s[20:23], s11 offen sc1
    v_add_f32 v72, v72, v88
    v_mfma_f32_16x16x32_bf16 v[28:31], a[40:43], v[168:171], v[28:31]
    v_add_f32 v73, v73, v89
    v_add_f32 v74, v74, v90
    v_mfma_f32_16x16x32_bf16 v[44:47], a[40:43], v[172:175], v[44:47]
    v_add_f32 v75, v75, v91
    v_add_f32 v72, v72, v104
    v_mfma_f32_16x16x32_bf16 v[60:63], a[40:43], v[176:179], v[60:63]
    v_add_f32 v73, v73, v105
    v_add_f32 v74, v74, v106
    v_mfma_f32_16x16x32_bf16 v[16:19], a[44:47], v[164:167], v[16:19]
    buffer_load_dwordx4 v[160:163], v239, s[20:23], s11 offen sc1
    v_mfma_f32_16x16x32_bf16 v[32:35], a[44:47], v[168:171], v[32:35]
    v_add_f32 v75, v75, v107
    v_add_f32 v72, v72, v120
    v_mfma_f32_16x16x32_bf16 v[48:51], a[44:47], v[172:175], v[48:51]
    v_add_f32 v73, v73, v121
    v_add_f32 v74, v74, v122
    v_mfma_f32_16x16x32_bf16 v[64:67], a[44:47], v[176:179], v[64:67]
    v_add_f32 v75, v75, v123
    buffer_store_dwordx4 v[72:75], v241, s[44:47], s93 offen offset:1024 sc1
    s_waitcnt vmcnt(10) lgkmcnt(0)
    v_mfma_f32_16x16x32_bf16 v[4:7], a[48:51], v[180:183], v[4:7]
    s_add_u32 s11, s6, 6
    s_and_b32 s11, s11, 15
    s_lshl_b32 s11, s11, 10
    s_add_u32 s11, s11, s13
    buffer_load_dwordx4 v[164:167], v236, s[20:23], s11 offen sc1
    v_add_f32 v76, v76, v92
    v_mfma_f32_16x16x32_bf16 v[20:23], a[48:51], v[184:187], v[20:23]
    v_add_f32 v77, v77, v93
    v_add_f32 v78, v78, v94
    v_mfma_f32_16x16x32_bf16 v[36:39], a[48:51], v[188:191], v[36:39]
    v_add_f32 v79, v79, v95
    v_add_f32 v76, v76, v108
    v_mfma_f32_16x16x32_bf16 v[52:55], a[48:51], v[192:195], v[52:55]
    v_add_f32 v77, v77, v109
    v_add_f32 v78, v78, v110
    v_mfma_f32_16x16x32_bf16 v[8:11], a[52:55], v[180:183], v[8:11]
    buffer_load_dwordx4 v[168:171], v237, s[20:23], s11 offen sc1
    v_mfma_f32_16x16x32_bf16 v[24:27], a[52:55], v[184:187], v[24:27]
    v_add_f32 v79, v79, v111
    v_add_f32 v76, v76, v124
    v_mfma_f32_16x16x32_bf16 v[40:43], a[52:55], v[188:191], v[40:43]
    v_add_f32 v77, v77, v125
    v_add_f32 v78, v78, v126
    v_mfma_f32_16x16x32_bf16 v[56:59], a[52:55], v[192:195], v[56:59]
    v_add_f32 v79, v79, v127
    buffer_store_dwordx4 v[76:79], v241, s[44:47], s93 offen offset:2048 sc1
    v_mfma_f32_16x16x32_bf16 v[12:15], a[56:59], v[180:183], v[12:15]
    buffer_load_dwordx4 v[172:175], v238, s[20:23], s11 offen sc1
    v_add_f32 v80, v80, v96
    v_mfma_f32_16x16x32_bf16 v[28:31], a[56:59], v[184:187], v[28:31]
    v_add_f32 v81, v81, v97
    v_add_f32 v82, v82, v98
    v_mfma_f32_16x16x32_bf16 v[44:47], a[56:59], v[188:191], v[44:47]
    v_add_f32 v83, v83, v99
    v_add_f32 v80, v80, v112
    v_mfma_f32_16x16x32_bf16 v[60:63], a[56:59], v[192:195], v[60:63]
    v_add_f32 v81, v81, v113
    v_add_f32 v82, v82, v114
    v_mfma_f32_16x16x32_bf16 v[16:19], a[60:63], v[180:183], v[16:19]
    buffer_load_dwordx4 v[176:179], v239, s[20:23], s11 offen sc1
    v_mfma_f32_16x16x32_bf16 v[32:35], a[60:63], v[184:187], v[32:35]
    v_add_f32 v83, v83, v115
    v_add_f32 v80, v80, v128
    v_mfma_f32_16x16x32_bf16 v[48:51], a[60:63], v[188:191], v[48:51]
    v_add_f32 v81, v81, v129
    v_add_f32 v82, v82, v130
    v_mfma_f32_16x16x32_bf16 v[64:67], a[60:63], v[192:195], v[64:67]
    v_add_f32 v83, v83, v131
    buffer_store_dwordx4 v[80:83], v241, s[44:47], s93 offen offset:3072 sc1
    s_waitcnt vmcnt(12) lgkmcnt(0)
    v_mfma_f32_16x16x32_bf16 v[4:7], a[64:67], v[132:135], v[4:7]
    s_add_u32 s11, s6, 7
    s_and_b32 s11, s11, 15
    s_lshl_b32 s11, s11, 10
    s_add_u32 s11, s11, s13
    buffer_load_dwordx4 v[180:183], v236, s[20:23], s11 offen sc1
    v_mfma_f32_16x16x32_bf16 v[20:23], a[64:67], v[136:139], v[20:23]
    v_mfma_f32_16x16x32_bf16 v[36:39], a[64:67], v[140:143], v[36:39]
    v_mfma_f32_16x16x32_bf16 v[52:55], a[64:67], v[144:147], v[52:55]
    v_mfma_f32_16x16x32_bf16 v[8:11], a[68:71], v[132:135], v[8:11]
    buffer_load_dwordx4 v[184:187], v237, s[20:23], s11 offen sc1
    v_mfma_f32_16x16x32_bf16 v[24:27], a[68:71], v[136:139], v[24:27]
    v_mfma_f32_16x16x32_bf16 v[40:43], a[68:71], v[140:143], v[40:43]
    v_mfma_f32_16x16x32_bf16 v[56:59], a[68:71], v[144:147], v[56:59]
    v_mfma_f32_16x16x32_bf16 v[12:15], a[72:75], v[132:135], v[12:15]
    buffer_load_dwordx4 v[188:191], v238, s[20:23], s11 offen sc1
    v_mfma_f32_16x16x32_bf16 v[28:31], a[72:75], v[136:139], v[28:31]
    v_mfma_f32_16x16x32_bf16 v[44:47], a[72:75], v[140:143], v[44:47]
    v_mfma_f32_16x16x32_bf16 v[60:63], a[72:75], v[144:147], v[60:63]
    v_mfma_f32_16x16x32_bf16 v[16:19], a[76:79], v[132:135], v[16:19]
    buffer_load_dwordx4 v[192:195], v239, s[20:23], s11 offen sc1
    v_mfma_f32_16x16x32_bf16 v[32:35], a[76:79], v[136:139], v[32:35]
    v_mfma_f32_16x16x32_bf16 v[48:51], a[76:79], v[140:143], v[48:51]
    v_mfma_f32_16x16x32_bf16 v[64:67], a[76:79], v[144:147], v[64:67]
    s_waitcnt vmcnt(11) lgkmcnt(0)
    v_mfma_f32_16x16x32_bf16 v[4:7], a[80:83], v[148:151], v[4:7]
    s_add_u32 s11, s6, 8
    s_and_b32 s11, s11, 15
    s_lshl_b32 s11, s11, 10
    s_add_u32 s11, s11, s13
    buffer_load_dwordx4 v[132:135], v236, s[20:23], s11 offen sc1
    v_mfma_f32_16x16x32_bf16 v[20:23], a[80:83], v[152:155], v[20:23]
    v_mfma_f32_16x16x32_bf16 v[36:39], a[80:83], v[156:159], v[36:39]
    v_mfma_f32_16x16x32_bf16 v[52:55], a[80:83], v[160:163], v[52:55]
    v_mfma_f32_16x16x32_bf16 v[8:11], a[84:87], v[148:151], v[8:11]
    buffer_load_dwordx4 v[136:139], v237, s[20:23], s11 offen sc1
    v_mfma_f32_16x16x32_bf16 v[24:27], a[84:87], v[152:155], v[24:27]
    v_mfma_f32_16x16x32_bf16 v[40:43], a[84:87], v[156:159], v[40:43]
    v_mfma_f32_16x16x32_bf16 v[56:59], a[84:87], v[160:163], v[56:59]
    v_mfma_f32_16x16x32_bf16 v[12:15], a[88:91], v[148:151], v[12:15]
    buffer_load_dwordx4 v[140:143], v238, s[20:23], s11 offen sc1
    v_mfma_f32_16x16x32_bf16 v[28:31], a[88:91], v[152:155], v[28:31]
    v_mfma_f32_16x16x32_bf16 v[44:47], a[88:91], v[156:159], v[44:47]
    v_mfma_f32_16x16x32_bf16 v[60:63], a[88:91], v[160:163], v[60:63]
    v_mfma_f32_16x16x32_bf16 v[16:19], a[92:95], v[148:151], v[16:19]
    buffer_load_dwordx4 v[144:147], v239, s[20:23], s11 offen sc1
    v_mfma_f32_16x16x32_bf16 v[32:35], a[92:95], v[152:155], v[32:35]
    v_mfma_f32_16x16x32_bf16 v[48:51], a[92:95], v[156:159], v[48:51]
    v_mfma_f32_16x16x32_bf16 v[64:67], a[92:95], v[160:163], v[64:67]
    s_waitcnt vmcnt(9) lgkmcnt(0)
    v_mfma_f32_16x16x32_bf16 v[4:7], a[96:99], v[164:167], v[4:7]
    s_add_u32 s11, s6, 9
    s_and_b32 s11, s11, 15
    s_lshl_b32 s11, s11, 10
    s_add_u32 s11, s11, s13
    buffer_load_dwordx4 v[148:151], v236, s[20:23], s11 offen sc1
    v_mfma_f32_16x16x32_bf16 v[20:23], a[96:99], v[168:171], v[20:23]
    v_mfma_f32_16x16x32_bf16 v[36:39], a[96:99], v[172:175], v[36:39]
    v_mfma_f32_16x16x32_bf16 v[52:55], a[96:99], v[176:179], v[52:55]
    v_mfma_f32_16x16x32_bf16 v[8:11], a[100:103], v[164:167], v[8:11]
    buffer_load_dwordx4 v[152:155], v237, s[20:23], s11 offen sc1
    v_mfma_f32_16x16x32_bf16 v[24:27], a[100:103], v[168:171], v[24:27]
    v_mfma_f32_16x16x32_bf16 v[40:43], a[100:103], v[172:175], v[40:43]
    v_mfma_f32_16x16x32_bf16 v[56:59], a[100:103], v[176:179], v[56:59]
    v_mfma_f32_16x16x32_bf16 v[12:15], a[104:107], v[164:167], v[12:15]
    buffer_load_dwordx4 v[156:159], v238, s[20:23], s11 offen sc1
    v_mfma_f32_16x16x32_bf16 v[28:31], a[104:107], v[168:171], v[28:31]
    v_mfma_f32_16x16x32_bf16 v[44:47], a[104:107], v[172:175], v[44:47]
    v_mfma_f32_16x16x32_bf16 v[60:63], a[104:107], v[176:179], v[60:63]
    v_mfma_f32_16x16x32_bf16 v[16:19], a[108:111], v[164:167], v[16:19]
    buffer_load_dwordx4 v[160:163], v239, s[20:23], s11 offen sc1
    v_mfma_f32_16x16x32_bf16 v[32:35], a[108:111], v[168:171], v[32:35]
    v_mfma_f32_16x16x32_bf16 v[48:51], a[108:111], v[172:175], v[48:51]
    v_mfma_f32_16x16x32_bf16 v[64:67], a[108:111], v[176:179], v[64:67]
    s_waitcnt vmcnt(8) lgkmcnt(0)
    s_barrier
    s_cmp_lg_u32 s52, 0
    s_cbranch_scc1 L1_pub2
    s_mov_b64 exec, 1
    buffer_store_dword v250, off, s[80:83], s95 sc1
    s_mov_b64 exec, -1
L1_pub2:
    v_mfma_f32_16x16x32_bf16 v[4:7], a[112:115], v[180:183], v[4:7]
    s_add_u32 s11, s6, 10
    s_and_b32 s11, s11, 15
    s_lshl_b32 s11, s11, 10
    s_add_u32 s11, s11, s13
    buffer_load_dwordx4 v[164:167], v236, s[20:23], s11 offen sc1
    v_mfma_f32_16x16x32_bf16 v[20:23], a[112:115], v[184:187], v[20:23]
    v_mfma_f32_16x16x32_bf16 v[36:39], a[112:115], v[188:191], v[36:39]
    v_mfma_f32_16x16x32_bf16 v[52:55], a[112:115], v[192:195], v[52:55]
    v_mfma_f32_16x16x32_bf16 v[8:11], a[116:119], v[180:183], v[8:11]
    buffer_load_dwordx4 v[168:171], v237, s[20:23], s11 offen sc1
    v_mfma_f32_16x16x32_bf16 v[24:27], a[116:119], v[184:187], v[24:27]
    v_mfma_f32_16x16x32_bf16 v[40:43], a[116:119], v[188:191], v[40:43]
    v_mfma_f32_16x16x32_bf16 v[56:59], a[116:119], v[192:195], v[56:59]
    v_mfma_f32_16x16x32_bf16 v[12:15], a[120:123], v[180:183], v[12:15]
    buffer_load_dwordx4 v[172:175], v238, s[20:23], s11 offen sc1
    v_mfma_f32_16x16x32_bf16 v[28:31], a[120:123], v[184:187], v[28:31]
    v_mfma_f32_16x16x32_bf16 v[44:47], a[120:123], v[188:191], v[44:47]
    v_mfma_f32_16x16x32_bf16 v[60:63], a[120:123], v[192:195], v[60:63]
    v_mfma_f32_16x16x32_bf16 v[16:19], a[124:127], v[180:183], v[16:19]
    buffer_load_dwordx4 v[176:179], v239, s[20:23], s11 offen sc1
    v_mfma_f32_16x16x32_bf16 v[32:35], a[124:127], v[184:187], v[32:35]
    v_mfma_f32_16x16x32_bf16 v[48:51], a[124:127], v[188:191], v[48:51]
    v_mfma_f32_16x16x32_bf16 v[64:67], a[124:127], v[192:195], v[64:67]
    s_waitcnt vmcnt(8) lgkmcnt(0)
    v_mfma_f32_16x16x32_bf16 v[4:7], a[128:131], v[132:135], v[4:7]
    s_add_u32 s11, s6, 11
    s_and_b32 s11, s11, 15
    s_lshl_b32 s11, s11, 10
    s_add_u32 s11, s11, s13
    buffer_load_dwordx4 v[180:183], v236, s[20:23], s11 offen sc1
    v_mfma_f32_16x16x32_bf16 v[20:23], a[128:131], v[136:139], v[20:23]
    v_mfma_f32_16x16x32_bf16 v[36:39], a[128:131], v[140:143], v[36:39]
    v_mfma_f32_16x16x32_bf16 v[52:55], a[128:131], v[144:147], v[52:55]
    v_mfma_f32_16x16x32_bf16 v[8:11], a[132:135], v[132:135], v[8:11]
    buffer_load_dwordx4 v[184:187], v237, s[20:23], s11 offen sc1
    v_mfma_f32_16x16x32_bf16 v[24:27], a[132:135], v[136:139], v[24:27]
    v_mfma_f32_16x16x32_bf16 v[40:43], a[132:135], v[140:143], v[40:43]
    v_mfma_f32_16x16x32_bf16 v[56:59], a[132:135], v[144:147], v[56:59]
    v_mfma_f32_16x16x32_bf16 v[12:15], a[136:139], v[132:135], v[12:15]
    buffer_load_dwordx4 v[188:191], v238, s[20:23], s11 offen sc1
    v_mfma_f32_16x16x32_bf16 v[28:31], a[136:139], v[136:139], v[28:31]
    v_mfma_f32_16x16x32_bf16 v[44:47], a[136:139], v[140:143], v[44:47]
    v_mfma_f32_16x16x32_bf16 v[60:63], a[136:139], v[144:147], v[60:63]
    v_mfma_f32_16x16x32_bf16 v[16:19], a[140:143], v[132:135], v[16:19]
    buffer_load_dwordx4 v[192:195], v239, s[20:23], s11 offen sc1
    v_mfma_f32_16x16x32_bf16 v[32:35], a[140:143], v[136:139], v[32:35]
    v_mfma_f32_16x16x32_bf16 v[48:51], a[140:143], v[140:143], v[48:51]
    v_mfma_f32_16x16x32_bf16 v[64:67], a[140:143], v[144:147], v[64:67]
    s_waitcnt vmcnt(8) lgkmcnt(0)
    v_mfma_f32_16x16x32_bf16 v[4:7], a[144:147], v[148:151], v[4:7]
    s_add_u32 s11, s6, 12
    s_and_b32 s11, s11, 15
    s_lshl_b32 s11, s11, 10
    s_add_u32 s11, s11, s13
    buffer_load_dwordx4 v[132:135], v236, s[20:23], s11 offen sc1
    v_mfma_f32_16x16x32_bf16 v[20:23], a[144:147], v[152:155], v[20:23]
    v_mfma_f32_16x16x32_bf16 v[36:39], a[144:147], v[156:159], v[36:39]
    v_mfma_f32_16x16x32_bf16 v[52:55], a[144:147], v[160:163], v[52:55]
    v_mfma_f32_16x16x32_bf16 v[8:11], a[148:151], v[148:151], v[8:11]
    buffer_load_dwordx4 v[136:139], v237, s[20:23], s11 offen sc1
    v_mfma_f32_16x16x32_bf16 v[24:27], a[148:151], v[152:155], v[24:27]
    v_mfma_f32_16x16x32_bf16 v[40:43], a[148:151], v[156:159], v[40:43]
    v_mfma_f32_16x16x32_bf16 v[56:59], a[148:151], v[160:163], v[56:59]
    v_mfma_f32_16x16x32_bf16 v[12:15], a[152:155], v[148:151], v[12:15]
    buffer_load_dwordx4 v[140:143], v238, s[20:23], s11 offen sc1
    v_mfma_f32_16x16x32_bf16 v[28:31], a[152:155], v[152:155], v[28:31]
    v_mfma_f32_16x16x32_bf16 v[44:47], a[152:155], v[156:159], v[44:47]
    v_mfma_f32_16x16x32_bf16 v[60:63], a[152:155], v[160:163], v[60:63]
    v_mfma_f32_16x16x32_bf16 v[16:19], a[156:159], v[148:151], v[16:19]
    buffer_load_dwordx4 v[144:147], v239, s[20:23], s11 offen sc1
    v_mfma_f32_16x16x32_bf16 v[32:35], a[156:159], v[152:155], v[32:35]
    v_mfma_f32_16x16x32_bf16 v[48:51], a[156:159], v[156:159], v[48:51]
    v_mfma_f32_16x16x32_bf16 v[64:67], a[156:159], v[160:163], v[64:67]
    s_waitcnt vmcnt(8) lgkmcnt(0)
    v_mfma_f32_16x16x32_bf16 v[4:7], a[160:163], v[164:167], v[4:7]
    s_add_u32 s11, s6, 13
    s_and_b32 s11, s11, 15
    s_lshl_b32 s11, s11, 10
    s_add_u32 s11, s11, s13
    buffer_load_dwordx4 v[148:151], v236, s[20:23], s11 offen sc1
    v_mfma_f32_16x16x32_bf16 v[20:23], a[160:163], v[168:171], v[20:23]
    v_mfma_f32_16x16x32_bf16 v[36:39], a[160:163], v[172:175], v[36:39]
    v_mfma_f32_16x16x32_bf16 v[52:55], a[160:163], v[176:179], v[52:55]
    v_mfma_f32_16x16x32_bf16 v[8:11], a[164:167], v[164:167], v[8:11]
    buffer_load_dwordx4 v[152:155], v237, s[20:23], s11 offen sc1
    v_mfma_f32_16x16x32_bf16 v[24:27], a[164:167], v[168:171], v[24:27]
    v_mfma_f32_16x16x32_bf16 v[40:43], a[164:167], v[172:175], v[40:43]
    v_mfma_f32_16x16x32_bf16 v[56:59], a[164:167], v[176:179], v[56:59]
    v_mfma_f32_16x16x32_bf16 v[12:15], a[168:171], v[164:167], v[12:15]
    buffer_load_dwordx4 v[156:159], v238, s[20:23], s11 offen sc1
    v_mfma_f32_16x16x32_bf16 v[28:31], a[168:171], v[168:171], v[28:31]
    v_mfma_f32_16x16x32_bf16 v[44:47], a[168:171], v[172:175], v[44:47]
    v_mfma_f32_16x16x32_bf16 v[60:63], a[168:171], v[176:179], v[60:63]
    v_mfma_f32_16x16x32_bf16 v[16:19], a[172:175], v[164:167], v[16:19]
    buffer_load_dwordx4 v[160:163], v239, s[20:23], s11 offen sc1
    v_mfma_f32_16x16x32_bf16 v[32:35], a[172:175], v[168:171], v[32:35]
    v_mfma_f32_16x16x32_bf16 v[48:51], a[172:175], v[172:175], v[48:51]
    buffer_load_dword v213, off, s[80:83], s96 sc1
    v_mfma_f32_16x16x32_bf16 v[64:67], a[172:175], v[176:179], v[64:67]
    s_waitcnt vmcnt(9) lgkmcnt(0)
    v_mfma_f32_16x16x32_bf16 v[4:7], a[176:179], v[180:183], v[4:7]
    s_add_u32 s11, s6, 14
    s_and_b32 s11, s11, 15
    s_lshl_b32 s11, s11, 10
    s_add_u32 s11, s11, s13
    buffer_load_dwordx4 v[164:167], v236, s[20:23], s11 offen sc1
    v_mfma_f32_16x16x32_bf16 v[20:23], a[176:179], v[184:187], v[20:23]
    v_mfma_f32_16x16x32_bf16 v[36:39], a[176:179], v[188:191], v[36:39]
    v_mfma_f32_16x16x32_bf16 v[52:55], a[176:179], v[192:195], v[52:55]
    v_mfma_f32_16x16x32_bf16 v[8:11], a[180:183], v[180:183], v[8:11]
    buffer_load_dwordx4 v[168:171], v237, s[20:23], s11 offen sc1
    v_mfma_f32_16x16x32_bf16 v[24:27], a[180:183], v[184:187], v[24:27]
    v_mfma_f32_16x16x32_bf16 v[40:43], a[180:183], v[188:191], v[40:43]
    v_mfma_f32_16x16x32_bf16 v[56:59], a[180:183], v[192:195], v[56:59]
    v_mfma_f32_16x16x32_bf16 v[12:15], a[184:187], v[180:183], v[12:15]
    buffer_load_dwordx4 v[172:175], v238, s[20:23], s11 offen sc1
    v_mfma_f32_16x16x32_bf16 v[28:31], a[184:187], v[184:187], v[28:31]
    v_mfma_f32_16x16x32_bf16 v[44:47], a[184:187], v[188:191], v[44:47]
    v_mfma_f32_16x16x32_bf16 v[60:63], a[184:187], v[192:195], v[60:63]
    v_mfma_f32_16x16x32_bf16 v[16:19], a[188:191], v[180:183], v[16:19]
    buffer_load_dwordx4 v[176:179], v239, s[20:23], s11 offen sc1
    v_mfma_f32_16x16x32_bf16 v[32:35], a[188:191], v[184:187], v[32:35]
    v_mfma_f32_16x16x32_bf16 v[48:51], a[188:191], v[188:191], v[48:51]
    v_mfma_f32_16x16x32_bf16 v[64:67], a[188:191], v[192:195], v[64:67]
    s_waitcnt vmcnt(9) lgkmcnt(0)
    v_mfma_f32_16x16x32_bf16 v[4:7], a[192:195], v[132:135], v[4:7]
    s_add_u32 s11, s6, 15
    s_and_b32 s11, s11, 15
    s_lshl_b32 s11, s11, 10
    s_add_u32 s11, s11, s13
    buffer_load_dwordx4 v[180:183], v236, s[20:23], s11 offen sc1
    v_mfma_f32_16x16x32_bf16 v[20:23], a[192:195], v[136:139], v[20:23]
    v_mfma_f32_16x16x32_bf16 v[36:39], a[192:195], v[140:143], v[36:39]
    v_mfma_f32_16x16x32_bf16 v[52:55], a[192:195], v[144:147], v[52:55]
    v_mfma_f32_16x16x32_bf16 v[8:11], a[196:199], v[132:135], v[8:11]
    buffer_load_dwordx4 v[184:187], v237, s[20:23], s11 offen sc1
    v_mfma_f32_16x16x32_bf16 v[24:27], a[196:199], v[136:139], v[24:27]
    v_mfma_f32_16x16x32_bf16 v[40:43], a[196:199], v[140:143], v[40:43]
    v_mfma_f32_16x16x32_bf16 v[56:59], a[196:199], v[144:147], v[56:59]
    v_mfma_f32_16x16x32_bf16 v[12:15], a[200:203], v[132:135], v[12:15]
    buffer_load_dwordx4 v[188:191], v238, s[20:23], s11 offen sc1
    v_mfma_f32_16x16x32_bf16 v[28:31], a[200:203], v[136:139], v[28:31]
    v_mfma_f32_16x16x32_bf16 v[44:47], a[200:203], v[140:143], v[44:47]
    v_mfma_f32_16x16x32_bf16 v[60:63], a[200:203], v[144:147], v[60:63]
    v_mfma_f32_16x16x32_bf16 v[16:19], a[204:207], v[132:135], v[16:19]
    buffer_load_dwordx4 v[192:195], v239, s[20:23], s11 offen sc1
    v_mfma_f32_16x16x32_bf16 v[32:35], a[204:207], v[136:139], v[32:35]
    v_mfma_f32_16x16x32_bf16 v[48:51], a[204:207], v[140:143], v[48:51]
    v_mfma_f32_16x16x32_bf16 v[64:67], a[204:207], v[144:147], v[64:67]
    s_waitcnt vmcnt(9) lgkmcnt(0)
    v_mfma_f32_16x16x32_bf16 v[4:7], a[208:211], v[148:151], v[4:7]
    v_mfma_f32_16x16x32_bf16 v[20:23], a[208:211], v[152:155], v[20:23]
    v_mfma_f32_16x16x32_bf16 v[36:39], a[208:211], v[156:159], v[36:39]
    v_mfma_f32_16x16x32_bf16 v[52:55], a[208:211], v[160:163], v[52:55]
    v_mfma_f32_16x16x32_bf16 v[8:11], a[212:215], v[148:151], v[8:11]
    v_mfma_f32_16x16x32_bf16 v[24:27], a[212:215], v[152:155], v[24:27]
    v_mfma_f32_16x16x32_bf16 v[40:43], a[212:215], v[156:159], v[40:43]
    v_mfma_f32_16x16x32_bf16 v[56:59], a[212:215], v[160:163], v[56:59]
    v_mfma_f32_16x16x32_bf16 v[12:15], a[216:219], v[148:151], v[12:15]
    v_mfma_f32_16x16x32_bf16 v[28:31], a[216:219], v[152:155], v[28:31]
    v_mfma_f32_16x16x32_bf16 v[44:47], a[216:219], v[156:159], v[44:47]
    v_mfma_f32_16x16x32_bf16 v[60:63], a[216:219], v[160:163], v[60:63]
    v_mfma_f32_16x16x32_bf16 v[16:19], a[220:223], v[148:151], v[16:19]
    v_mfma_f32_16x16x32_bf16 v[32:35], a[220:223], v[152:155], v[32:35]
    v_mfma_f32_16x16x32_bf16 v[48:51], a[220:223], v[156:159], v[48:51]
    v_mfma_f32_16x16x32_bf16 v[64:67], a[220:223], v[160:163], v[64:67]
    s_waitcnt vmcnt(4) lgkmcnt(0)
    v_cmp_ne_u32 vcc, 1, v213
    s_nop 0
    s_cbranch_vccnz L1_late
    buffer_load_dwordx4 v[196:199], v241, s[44:47], s94 offen offset:0 sc1
    buffer_load_dwordx4 v[200:203], v241, s[44:47], s94 offen offset:1024 sc1
    buffer_load_dwordx4 v[204:207], v241, s[44:47], s94 offen offset:2048 sc1
    buffer_load_dwordx4 v[208:211], v241, s[44:47], s94 offen offset:3072 sc1
    s_mov_b32 s14, 1
L1_late:
    v_mfma_f32_16x16x32_bf16 v[4:7], a[224:227], v[164:167], v[4:7]
    v_mfma_f32_16x16x32_bf16 v[20:23], a[224:227], v[168:171], v[20:23]
    v_mfma_f32_16x16x32_bf16 v[36:39], a[224:227], v[172:175], v[36:39]
    v_mfma_f32_16x16x32_bf16 v[52:55], a[224:227], v[176:179], v[52:55]
    v_mfma_f32_16x16x32_bf16 v[8:11], a[228:231], v[164:167], v[8:11]
    v_mfma_f32_16x16x32_bf16 v[24:27], a[228:231], v[168:171], v[24:27]
    v_mfma_f32_16x16x32_bf16 v[40:43], a[228:231], v[172:175], v[40:43]
    v_mfma_f32_16x16x32_bf16 v[56:59], a[228:231], v[176:179], v[56:59]
    v_mfma_f32_16x16x32_bf16 v[12:15], a[232:235], v[164:167], v[12:15]
    v_mfma_f32_16x16x32_bf16 v[28:31], a[232:235], v[168:171], v[28:31]
    v_mfma_f32_16x16x32_bf16 v[44:47], a[232:235], v[172:175], v[44:47]
    v_mfma_f32_16x16x32_bf16 v[60:63], a[232:235], v[176:179], v[60:63]
    v_mfma_f32_16x16x32_bf16 v[16:19], a[236:239], v[164:167], v[16:19]
    v_mfma_f32_16x16x32_bf16 v[32:35], a[236:239], v[168:171], v[32:35]
    v_mfma_f32_16x16x32_bf16 v[48:51], a[236:239], v[172:175], v[48:51]
    v_mfma_f32_16x16x32_bf16 v[64:67], a[236:239], v[176:179], v[64:67]
    s_cmp_eq_u32 s14, 1
    s_cbranch_scc1 L1_w31
    s_waitcnt vmcnt(0)
L1_w31:
    s_waitcnt vmcnt(4) lgkmcnt(0)
    v_mfma_f32_16x16x32_bf16 v[20:23], a[240:243], v[184:187], v[20:23]
    v_mfma_f32_16x16x32_bf16 v[24:27], a[244:247], v[184:187], v[24:27]
    v_mfma_f32_16x16x32_bf16 v[28:31], a[248:251], v[184:187], v[28:31]
    v_mfma_f32_16x16x32_bf16 v[32:35], a[252:255], v[184:187], v[32:35]
    v_mfma_f32_16x16x32_bf16 v[36:39], a[240:243], v[188:191], v[36:39]
    v_mfma_f32_16x16x32_bf16 v[40:43], a[244:247], v[188:191], v[40:43]
    v_mfma_f32_16x16x32_bf16 v[44:47], a[248:251], v[188:191], v[44:47]
    v_mfma_f32_16x16x32_bf16 v[48:51], a[252:255], v[188:191], v[48:51]
    v_mfma_f32_16x16x32_bf16 v[52:55], a[240:243], v[192:195], v[52:55]
    ds_write_b128 v242, v[20:23] offset:0
    v_mfma_f32_16x16x32_bf16 v[56:59], a[244:247], v[192:195], v[56:59]
    ds_write_b128 v242, v[24:27] offset:1024
    v_mfma_f32_16x16x32_bf16 v[60:63], a[248:251], v[192:195], v[60:63]
    ds_write_b128 v242, v[28:31] offset:2048
    v_mfma_f32_16x16x32_bf16 v[64:67], a[252:255], v[192:195], v[64:67]
    ds_write_b128 v242, v[32:35] offset:3072
    v_mfma_f32_16x16x32_bf16 v[4:7], a[240:243], v[180:183], v[4:7]
    ds_write_b128 v242, v[36:39] offset:4096
    v_mfma_f32_16x16x32_bf16 v[8:11], a[244:247], v[180:183], v[8:11]
    ds_write_b128 v242, v[40:43] offset:5120
    v_mfma_f32_16x16x32_bf16 v[12:15], a[248:251], v[180:183], v[12:15]
    ds_write_b128 v242, v[44:47] offset:6144
    v_mfma_f32_16x16x32_bf16 v[16:19], a[252:255], v[180:183], v[16:19]
    ds_write_b128 v242, v[48:51] offset:7168
    ds_write_b128 v242, v[52:55] offset:8192
    ds_write_b128 v242, v[56:59] offset:9216
    ds_write_b128 v242, v[60:63] offset:10240
    ds_write_b128 v242, v[64:67] offset:11264
    s_cmp_eq_u32 s14, 0
    s_cbranch_scc1 L1_wait2
L1_got2:
    s_waitcnt lgkmcnt(0)
    s_barrier
    ds_read_b128 v[20:23], v243 offset:0
    ds_read_b128 v[36:39], v244 offset:4096
    ds_read_b128 v[52:55], v245 offset:8192
    ds_read_b128 v[24:27], v243 offset:1024
    ds_read_b128 v[40:43], v244 offset:5120
    ds_read_b128 v[56:59], v245 offset:9216
    ds_read_b128 v[28:31], v243 offset:2048
    ds_read_b128 v[44:47], v244 offset:6144
    ds_read_b128 v[60:63], v245 offset:10240
    ds_read_b128 v[32:35], v243 offset:3072
    ds_read_b128 v[48:51], v244 offset:7168
    ds_read_b128 v[64:67], v245 offset:11264
    s_waitcnt vmcnt(0)
    v_pk_add_f32 v[4:5], v[4:5], v[196:197]
    v_pk_add_f32 v[6:7], v[6:7], v[198:199]
    s_waitcnt lgkmcnt(9)
    v_pk_add_f32 v[4:5], v[4:5], v[20:21]
    v_pk_add_f32 v[36:37], v[36:37], v[52:53]
    v_pk_add_f32 v[6:7], v[6:7], v[22:23]
    v_pk_add_f32 v[38:39], v[38:39], v[54:55]
    v_pk_add_f32 v[4:5], v[4:5], v[36:37]
    v_pk_add_f32 v[6:7], v[6:7], v[38:39]
    v_cvt_pk_bf16_f32 v4, v4, v5
    v_cvt_pk_bf16_f32 v5, v6, v7
    buffer_store_dwordx2 v[4:5], v246, s[40:43], s30 offen offset:0
    v_pk_add_f32 v[8:9], v[8:9], v[200:201]
    v_pk_add_f32 v[10:11], v[10:11], v[202:203]
    s_waitcnt lgkmcnt(6)
    v_pk_add_f32 v[8:9], v[8:9], v[24:25]
    v_pk_add_f32 v[40:41], v[40:41], v[56:57]
    v_pk_add_f32 v[10:11], v[10:11], v[26:27]
    v_pk_add_f32 v[42:43], v[42:43], v[58:59]
    v_pk_add_f32 v[8:9], v[8:9], v[40:41]
    v_pk_add_f32 v[10:11], v[10:11], v[42:43]
    v_cvt_pk_bf16_f32 v8, v8, v9
    v_cvt_pk_bf16_f32 v9, v10, v11
    buffer_store_dwordx2 v[8:9], v246, s[40:43], s30 offen offset:32
    v_pk_add_f32 v[12:13], v[12:13], v[204:205]
    v_pk_add_f32 v[14:15], v[14:15], v[206:207]
    s_waitcnt lgkmcnt(3)
    v_pk_add_f32 v[12:13], v[12:13], v[28:29]
    v_pk_add_f32 v[44:45], v[44:45], v[60:61]
    v_pk_add_f32 v[14:15], v[14:15], v[30:31]
    v_pk_add_f32 v[46:47], v[46:47], v[62:63]
    v_pk_add_f32 v[12:13], v[12:13], v[44:45]
    v_pk_add_f32 v[14:15], v[14:15], v[46:47]
    v_cvt_pk_bf16_f32 v12, v12, v13
    v_cvt_pk_bf16_f32 v13, v14, v15
    buffer_store_dwordx2 v[12:13], v246, s[40:43], s30 offen offset:64
    v_pk_add_f32 v[16:17], v[16:17], v[208:209]
    v_pk_add_f32 v[18:19], v[18:19], v[210:211]
    s_waitcnt lgkmcnt(0)
    v_pk_add_f32 v[16:17], v[16:17], v[32:33]
    v_pk_add_f32 v[48:49], v[48:49], v[64:65]
    v_pk_add_f32 v[18:19], v[18:19], v[34:35]
    v_pk_add_f32 v[50:51], v[50:51], v[66:67]
    v_pk_add_f32 v[16:17], v[16:17], v[48:49]
    v_pk_add_f32 v[18:19], v[18:19], v[50:51]
    v_cvt_pk_bf16_f32 v16, v16, v17
    v_cvt_pk_bf16_f32 v17, v18, v19
    buffer_store_dwordx2 v[16:17], v246, s[40:43], s30 offen offset:96
L1_end:
    s_endpgm
L1_wait2:
    buffer_load_dword v213, off, s[80:83], s96 sc1
    s_waitcnt vmcnt(0)
    v_cmp_ne_u32 vcc, 1, v213
    s_nop 0
    s_cbranch_vccnz L1_wait2
    buffer_load_dwordx4 v[196:199], v241, s[44:47], s94 offen offset:0 sc1
    buffer_load_dwordx4 v[200:203], v241, s[44:47], s94 offen offset:1024 sc1
    buffer_load_dwordx4 v[204:207], v241, s[44:47], s94 offen offset:2048 sc1
    buffer_load_dwordx4 v[208:211], v241, s[44:47], s94 offen offset:3072 sc1
    s_branch L1_got2
L1_cwait:
    buffer_load_dword v248, v247, s[84:87], 0 offen sc1
    s_waitcnt vmcnt(0)
    v_cmp_ne_u32 vcc, 0x80, v248
    s_nop 0
    s_cbranch_vccnz L1_cwait
    s_branch L1_cok
L1_slow:
    s_nop 7
    s_mov_b32 s42, 262144
    s_mov_b32 s46, 262144
    s_waitcnt vmcnt(0) lgkmcnt(0)
    v_mov_b32 v64, 0
    v_mov_b32 v65, 0
    v_mov_b32 v66, 0
    v_mov_b32 v67, 0
    v_mov_b32 v68, 0
    v_mov_b32 v69, 0
    v_mov_b32 v70, 0
    v_mov_b32 v71, 0
    v_mov_b32 v72, 0
    v_mov_b32 v73, 0
    v_mov_b32 v74, 0
    v_mov_b32 v75, 0
    v_mov_b32 v76, 0
    v_mov_b32 v77, 0
    v_mov_b32 v78, 0
    v_mov_b32 v79, 0
    v_mov_b32 v80, 0
    v_mov_b32 v81, 0
    v_mov_b32 v82, 0
    v_mov_b32 v83, 0
    v_mov_b32 v84, 0
    v_mov_b32 v85, 0
    v_mov_b32 v86, 0
    v_mov_b32 v87, 0
    v_mov_b32 v88, 0
    v_mov_b32 v89, 0
    v_mov_b32 v90, 0
    v_mov_b32 v91, 0
    v_mov_b32 v92, 0
    v_mov_b32 v93, 0
    v_mov_b32 v94, 0
    v_mov_b32 v95, 0
    v_mov_b32 v96, 0
    v_mov_b32 v97, 0
    v_mov_b32 v98, 0
    v_mov_b32 v99, 0
    v_mov_b32 v100, 0
    v_mov_b32 v101, 0
    v_mov_b32 v102, 0
    v_mov_b32 v103, 0
    v_mov_b32 v104, 0
    v_mov_b32 v105, 0
    v_mov_b32 v106, 0
    v_mov_b32 v107, 0
    v_mov_b32 v108, 0
    v_mov_b32 v109, 0
    v_mov_b32 v110, 0
    v_mov_b32 v111, 0
    v_mov_b32 v112, 0
    v_mov_b32 v113, 0
    v_mov_b32 v114, 0
    v_mov_b32 v115, 0
    v_mov_b32 v116, 0
    v_mov_b32 v117, 0
    v_mov_b32 v118, 0
    v_mov_b32 v119, 0
    v_mov_b32 v120, 0
    v_mov_b32 v121, 0
    v_mov_b32 v122, 0
    v_mov_b32 v123, 0
    v_mov_b32 v124, 0
    v_mov_b32 v125, 0
    v_mov_b32 v126, 0
    v_mov_b32 v127, 0
    v_mov_b32 v128, 0
    v_mov_b32 v129, 0
    v_mov_b32 v130, 0
    v_mov_b32 v131, 0
    v_mov_b32 v132, 0
    v_mov_b32 v133, 0
    v_mov_b32 v134, 0
    v_mov_b32 v135, 0
    v_mov_b32 v136, 0
    v_mov_b32 v137, 0
    v_mov_b32 v138, 0
    v_mov_b32 v139, 0
    v_mov_b32 v140, 0
    v_mov_b32 v141, 0
    v_mov_b32 v142, 0
    v_mov_b32 v143, 0
    v_mov_b32 v144, 0
    v_mov_b32 v145, 0
    v_mov_b32 v146, 0
    v_mov_b32 v147, 0
    v_mov_b32 v148, 0
    v_mov_b32 v149, 0
    v_mov_b32 v150, 0
    v_mov_b32 v151, 0
    v_mov_b32 v152, 0
    v_mov_b32 v153, 0
    v_mov_b32 v154, 0
    v_mov_b32 v155, 0
    v_mov_b32 v156, 0
    v_mov_b32 v157, 0
    v_mov_b32 v158, 0
    v_mov_b32 v159, 0
    v_mov_b32 v160, 0
    v_mov_b32 v161, 0
    v_mov_b32 v162, 0
    v_mov_b32 v163, 0
    v_mov_b32 v164, 0
    v_mov_b32 v165, 0
    v_mov_b32 v166, 0
    v_mov_b32 v167, 0
    v_mov_b32 v168, 0
    v_mov_b32 v169, 0
    v_mov_b32 v170, 0
    v_mov_b32 v171, 0
    v_mov_b32 v40, 0xff7fffff
    v_mov_b32 v44, 0xff7fffff
    v_mov_b32 v48, 0xff7fffff
    v_and_b32 v1, 15, v0
    v_lshrrev_b32 v2, 4, v0
    v_lshlrev_b32 v4, 8, v1
    v_lshl_add_u32 v4, v2, 4, v4
    v_add_u32 v5, 0x1000, v4
    v_lshlrev_b32 v6, 10, v2
    v_lshl_add_u32 v6, v1, 1, v6
    v_add_u32 v7, 0x1000, v6
    s_mov_b32 s58, 0
L1_slow_loop:
    buffer_load_dwordx4 a[0:3], v4, s[40:43], s58 offen offset:0
    buffer_load_dwordx4 a[4:7], v4, s[40:43], s58 offen offset:64
    buffer_load_dwordx4 a[8:11], v4, s[40:43], s58 offen offset:128
    buffer_load_dwordx4 a[12:15], v4, s[40:43], s58 offen offset:192
    buffer_load_dwordx4 a[16:19], v5, s[40:43], s58 offen offset:0
    buffer_load_dwordx4 a[20:23], v5, s[40:43], s58 offen offset:64
    buffer_load_dwordx4 a[24:27], v5, s[40:43], s58 offen offset:128
    buffer_load_dwordx4 a[28:31], v5, s[40:43], s58 offen offset:192
    buffer_load_ushort v8, v6, s[44:47], s58 offen offset:0
    buffer_load_ushort v9, v6, s[44:47], s58 offen offset:256
    buffer_load_ushort v10, v6, s[44:47], s58 offen offset:512
    buffer_load_ushort v11, v6, s[44:47], s58 offen offset:768
    buffer_load_ushort v12, v7, s[44:47], s58 offen offset:0
    buffer_load_ushort v13, v7, s[44:47], s58 offen offset:256
    buffer_load_ushort v14, v7, s[44:47], s58 offen offset:512
    buffer_load_ushort v15, v7, s[44:47], s58 offen offset:768
    s_waitcnt vmcnt(0)
    v_lshl_or_b32 v241, v9, 16, v8
    v_lshl_or_b32 v242, v11, 16, v10
    v_lshl_or_b32 v243, v13, 16, v12
    v_lshl_or_b32 v244, v15, 16, v14
    v_accvgpr_write_b32 a32, v241
    v_accvgpr_write_b32 a33, v242
    v_accvgpr_write_b32 a34, v243
    v_accvgpr_write_b32 a35, v244
    buffer_load_ushort v8, v6, s[44:47], s58 offen offset:32
    buffer_load_ushort v9, v6, s[44:47], s58 offen offset:288
    buffer_load_ushort v10, v6, s[44:47], s58 offen offset:544
    buffer_load_ushort v11, v6, s[44:47], s58 offen offset:800
    buffer_load_ushort v12, v7, s[44:47], s58 offen offset:32
    buffer_load_ushort v13, v7, s[44:47], s58 offen offset:288
    buffer_load_ushort v14, v7, s[44:47], s58 offen offset:544
    buffer_load_ushort v15, v7, s[44:47], s58 offen offset:800
    s_waitcnt vmcnt(0)
    v_lshl_or_b32 v241, v9, 16, v8
    v_lshl_or_b32 v242, v11, 16, v10
    v_lshl_or_b32 v243, v13, 16, v12
    v_lshl_or_b32 v244, v15, 16, v14
    v_accvgpr_write_b32 a36, v241
    v_accvgpr_write_b32 a37, v242
    v_accvgpr_write_b32 a38, v243
    v_accvgpr_write_b32 a39, v244
    buffer_load_ushort v8, v6, s[44:47], s58 offen offset:64
    buffer_load_ushort v9, v6, s[44:47], s58 offen offset:320
    buffer_load_ushort v10, v6, s[44:47], s58 offen offset:576
    buffer_load_ushort v11, v6, s[44:47], s58 offen offset:832
    buffer_load_ushort v12, v7, s[44:47], s58 offen offset:64
    buffer_load_ushort v13, v7, s[44:47], s58 offen offset:320
    buffer_load_ushort v14, v7, s[44:47], s58 offen offset:576
    buffer_load_ushort v15, v7, s[44:47], s58 offen offset:832
    s_waitcnt vmcnt(0)
    v_lshl_or_b32 v241, v9, 16, v8
    v_lshl_or_b32 v242, v11, 16, v10
    v_lshl_or_b32 v243, v13, 16, v12
    v_lshl_or_b32 v244, v15, 16, v14
    v_accvgpr_write_b32 a40, v241
    v_accvgpr_write_b32 a41, v242
    v_accvgpr_write_b32 a42, v243
    v_accvgpr_write_b32 a43, v244
    buffer_load_ushort v8, v6, s[44:47], s58 offen offset:96
    buffer_load_ushort v9, v6, s[44:47], s58 offen offset:352
    buffer_load_ushort v10, v6, s[44:47], s58 offen offset:608
    buffer_load_ushort v11, v6, s[44:47], s58 offen offset:864
    buffer_load_ushort v12, v7, s[44:47], s58 offen offset:96
    buffer_load_ushort v13, v7, s[44:47], s58 offen offset:352
    buffer_load_ushort v14, v7, s[44:47], s58 offen offset:608
    buffer_load_ushort v15, v7, s[44:47], s58 offen offset:864
    s_waitcnt vmcnt(0)
    v_lshl_or_b32 v241, v9, 16, v8
    v_lshl_or_b32 v242, v11, 16, v10
    v_lshl_or_b32 v243, v13, 16, v12
    v_lshl_or_b32 v244, v15, 16, v14
    v_accvgpr_write_b32 a44, v241
    v_accvgpr_write_b32 a45, v242
    v_accvgpr_write_b32 a46, v243
    v_accvgpr_write_b32 a47, v244
    buffer_load_ushort v8, v6, s[44:47], s58 offen offset:128
    buffer_load_ushort v9, v6, s[44:47], s58 offen offset:384
    buffer_load_ushort v10, v6, s[44:47], s58 offen offset:640
    buffer_load_ushort v11, v6, s[44:47], s58 offen offset:896
    buffer_load_ushort v12, v7, s[44:47], s58 offen offset:128
    buffer_load_ushort v13, v7, s[44:47], s58 offen offset:384
    buffer_load_ushort v14, v7, s[44:47], s58 offen offset:640
    buffer_load_ushort v15, v7, s[44:47], s58 offen offset:896
    s_waitcnt vmcnt(0)
    v_lshl_or_b32 v241, v9, 16, v8
    v_lshl_or_b32 v242, v11, 16, v10
    v_lshl_or_b32 v243, v13, 16, v12
    v_lshl_or_b32 v244, v15, 16, v14
    v_accvgpr_write_b32 a48, v241
    v_accvgpr_write_b32 a49, v242
    v_accvgpr_write_b32 a50, v243
    v_accvgpr_write_b32 a51, v244
    buffer_load_ushort v8, v6, s[44:47], s58 offen offset:160
    buffer_load_ushort v9, v6, s[44:47], s58 offen offset:416
    buffer_load_ushort v10, v6, s[44:47], s58 offen offset:672
    buffer_load_ushort v11, v6, s[44:47], s58 offen offset:928
    buffer_load_ushort v12, v7, s[44:47], s58 offen offset:160
    buffer_load_ushort v13, v7, s[44:47], s58 offen offset:416
    buffer_load_ushort v14, v7, s[44:47], s58 offen offset:672
    buffer_load_ushort v15, v7, s[44:47], s58 offen offset:928
    s_waitcnt vmcnt(0)
    v_lshl_or_b32 v241, v9, 16, v8
    v_lshl_or_b32 v242, v11, 16, v10
    v_lshl_or_b32 v243, v13, 16, v12
    v_lshl_or_b32 v244, v15, 16, v14
    v_accvgpr_write_b32 a52, v241
    v_accvgpr_write_b32 a53, v242
    v_accvgpr_write_b32 a54, v243
    v_accvgpr_write_b32 a55, v244
    buffer_load_ushort v8, v6, s[44:47], s58 offen offset:192
    buffer_load_ushort v9, v6, s[44:47], s58 offen offset:448
    buffer_load_ushort v10, v6, s[44:47], s58 offen offset:704
    buffer_load_ushort v11, v6, s[44:47], s58 offen offset:960
    buffer_load_ushort v12, v7, s[44:47], s58 offen offset:192
    buffer_load_ushort v13, v7, s[44:47], s58 offen offset:448
    buffer_load_ushort v14, v7, s[44:47], s58 offen offset:704
    buffer_load_ushort v15, v7, s[44:47], s58 offen offset:960
    s_waitcnt vmcnt(0)
    v_lshl_or_b32 v241, v9, 16, v8
    v_lshl_or_b32 v242, v11, 16, v10
    v_lshl_or_b32 v243, v13, 16, v12
    v_lshl_or_b32 v244, v15, 16, v14
    v_accvgpr_write_b32 a56, v241
    v_accvgpr_write_b32 a57, v242
    v_accvgpr_write_b32 a58, v243
    v_accvgpr_write_b32 a59, v244
    buffer_load_ushort v8, v6, s[44:47], s58 offen offset:224
    buffer_load_ushort v9, v6, s[44:47], s58 offen offset:480
    buffer_load_ushort v10, v6, s[44:47], s58 offen offset:736
    buffer_load_ushort v11, v6, s[44:47], s58 offen offset:992
    buffer_load_ushort v12, v7, s[44:47], s58 offen offset:224
    buffer_load_ushort v13, v7, s[44:47], s58 offen offset:480
    buffer_load_ushort v14, v7, s[44:47], s58 offen offset:736
    buffer_load_ushort v15, v7, s[44:47], s58 offen offset:992
    s_waitcnt vmcnt(0)
    v_lshl_or_b32 v241, v9, 16, v8
    v_lshl_or_b32 v242, v11, 16, v10
    v_lshl_or_b32 v243, v13, 16, v12
    v_lshl_or_b32 v244, v15, 16, v14
    v_accvgpr_write_b32 a60, v241
    v_accvgpr_write_b32 a61, v242
    v_accvgpr_write_b32 a62, v243
    v_accvgpr_write_b32 a63, v244
    v_mfma_f32_16x16x32_bf16 v[16:19], a[0:3], v[172:175], 0
    v_mfma_f32_16x16x32_bf16 v[16:19], a[4:7], v[176:179], v[16:19]
    v_mfma_f32_16x16x32_bf16 v[16:19], a[8:11], v[180:183], v[16:19]
    v_mfma_f32_16x16x32_bf16 v[16:19], a[12:15], v[184:187], v[16:19]
    v_mfma_f32_16x16x32_bf16 v[20:23], a[16:19], v[172:175], 0
    v_mfma_f32_16x16x32_bf16 v[20:23], a[20:23], v[176:179], v[20:23]
    v_mfma_f32_16x16x32_bf16 v[20:23], a[24:27], v[180:183], v[20:23]
    v_mfma_f32_16x16x32_bf16 v[20:23], a[28:31], v[184:187], v[20:23]
    s_nop 3
    v_max3_f32 v241, v16, v17, v18
    s_nop 2
    v_max3_f32 v242, v19, v20, v21
    v_max3_f32 v241, v241, v22, v23
    v_max_f32 v241, v241, v242
    v_mov_b32 v242, v241
    s_nop 1
    v_permlane16_swap_b32 v241, v242
    v_max_f32 v241, v241, v242
    v_mov_b32 v242, v241
    s_nop 1
    v_permlane32_swap_b32 v241, v242
    v_max3_f32 v241, v241, v242, v40
    v_sub_f32 v242, v40, v241
    v_exp_f32 v242, v242
    v_mov_b32 v40, v241
    v_sub_f32 v16, v16, v241
    v_sub_f32 v17, v17, v241
    v_sub_f32 v18, v18, v241
    v_sub_f32 v19, v19, v241
    v_sub_f32 v20, v20, v241
    v_sub_f32 v21, v21, v241
    v_sub_f32 v22, v22, v241
    v_sub_f32 v23, v23, v241
    v_exp_f32 v16, v16
    v_exp_f32 v17, v17
    v_exp_f32 v18, v18
    v_exp_f32 v19, v19
    v_exp_f32 v20, v20
    v_exp_f32 v21, v21
    v_exp_f32 v22, v22
    v_exp_f32 v23, v23
    v_mul_f32 v64, v64, v242
    v_mul_f32 v65, v65, v242
    v_mul_f32 v66, v66, v242
    v_mul_f32 v67, v67, v242
    v_mul_f32 v68, v68, v242
    v_mul_f32 v69, v69, v242
    v_mul_f32 v70, v70, v242
    v_mul_f32 v71, v71, v242
    v_mul_f32 v72, v72, v242
    v_mul_f32 v73, v73, v242
    v_mul_f32 v74, v74, v242
    v_mul_f32 v75, v75, v242
    v_mul_f32 v76, v76, v242
    v_mul_f32 v77, v77, v242
    v_mul_f32 v78, v78, v242
    v_mul_f32 v79, v79, v242
    v_mul_f32 v80, v80, v242
    v_mul_f32 v81, v81, v242
    v_mul_f32 v82, v82, v242
    v_mul_f32 v83, v83, v242
    v_mul_f32 v84, v84, v242
    v_mul_f32 v85, v85, v242
    v_mul_f32 v86, v86, v242
    v_mul_f32 v87, v87, v242
    v_mul_f32 v88, v88, v242
    v_mul_f32 v89, v89, v242
    v_mul_f32 v90, v90, v242
    v_mul_f32 v91, v91, v242
    v_mul_f32 v92, v92, v242
    v_mul_f32 v93, v93, v242
    v_mul_f32 v94, v94, v242
    v_mul_f32 v95, v95, v242
    v_mul_f32 v160, v160, v242
    v_mul_f32 v161, v161, v242
    v_mul_f32 v162, v162, v242
    v_mul_f32 v163, v163, v242
    v_cvt_pk_bf16_f32 v52, v16, v17
    v_cvt_pk_bf16_f32 v53, v18, v19
    v_cvt_pk_bf16_f32 v54, v20, v21
    v_cvt_pk_bf16_f32 v55, v22, v23
    s_nop 1
    v_mfma_f32_16x16x32_bf16 v[64:67], a[32:35], v[52:55], v[64:67]
    v_mfma_f32_16x16x32_bf16 v[68:71], a[36:39], v[52:55], v[68:71]
    v_mfma_f32_16x16x32_bf16 v[72:75], a[40:43], v[52:55], v[72:75]
    v_mfma_f32_16x16x32_bf16 v[76:79], a[44:47], v[52:55], v[76:79]
    v_mfma_f32_16x16x32_bf16 v[80:83], a[48:51], v[52:55], v[80:83]
    v_mfma_f32_16x16x32_bf16 v[84:87], a[52:55], v[52:55], v[84:87]
    v_mfma_f32_16x16x32_bf16 v[88:91], a[56:59], v[52:55], v[88:91]
    v_mfma_f32_16x16x32_bf16 v[92:95], a[60:63], v[52:55], v[92:95]
    v_mfma_f32_16x16x32_bf16 v[160:163], a[64:67], v[52:55], v[160:163]
    v_mfma_f32_16x16x32_bf16 v[24:27], a[0:3], v[188:191], 0
    v_mfma_f32_16x16x32_bf16 v[24:27], a[4:7], v[192:195], v[24:27]
    v_mfma_f32_16x16x32_bf16 v[24:27], a[8:11], v[196:199], v[24:27]
    v_mfma_f32_16x16x32_bf16 v[24:27], a[12:15], v[200:203], v[24:27]
    v_mfma_f32_16x16x32_bf16 v[28:31], a[16:19], v[188:191], 0
    v_mfma_f32_16x16x32_bf16 v[28:31], a[20:23], v[192:195], v[28:31]
    v_mfma_f32_16x16x32_bf16 v[28:31], a[24:27], v[196:199], v[28:31]
    v_mfma_f32_16x16x32_bf16 v[28:31], a[28:31], v[200:203], v[28:31]
    s_nop 3
    v_max3_f32 v241, v24, v25, v26
    s_nop 2
    v_max3_f32 v242, v27, v28, v29
    v_max3_f32 v241, v241, v30, v31
    v_max_f32 v241, v241, v242
    v_mov_b32 v242, v241
    s_nop 1
    v_permlane16_swap_b32 v241, v242
    v_max_f32 v241, v241, v242
    v_mov_b32 v242, v241
    s_nop 1
    v_permlane32_swap_b32 v241, v242
    v_max3_f32 v241, v241, v242, v44
    v_sub_f32 v242, v44, v241
    v_exp_f32 v242, v242
    v_mov_b32 v44, v241
    v_sub_f32 v24, v24, v241
    v_sub_f32 v25, v25, v241
    v_sub_f32 v26, v26, v241
    v_sub_f32 v27, v27, v241
    v_sub_f32 v28, v28, v241
    v_sub_f32 v29, v29, v241
    v_sub_f32 v30, v30, v241
    v_sub_f32 v31, v31, v241
    v_exp_f32 v24, v24
    v_exp_f32 v25, v25
    v_exp_f32 v26, v26
    v_exp_f32 v27, v27
    v_exp_f32 v28, v28
    v_exp_f32 v29, v29
    v_exp_f32 v30, v30
    v_exp_f32 v31, v31
    v_mul_f32 v96, v96, v242
    v_mul_f32 v97, v97, v242
    v_mul_f32 v98, v98, v242
    v_mul_f32 v99, v99, v242
    v_mul_f32 v100, v100, v242
    v_mul_f32 v101, v101, v242
    v_mul_f32 v102, v102, v242
    v_mul_f32 v103, v103, v242
    v_mul_f32 v104, v104, v242
    v_mul_f32 v105, v105, v242
    v_mul_f32 v106, v106, v242
    v_mul_f32 v107, v107, v242
    v_mul_f32 v108, v108, v242
    v_mul_f32 v109, v109, v242
    v_mul_f32 v110, v110, v242
    v_mul_f32 v111, v111, v242
    v_mul_f32 v112, v112, v242
    v_mul_f32 v113, v113, v242
    v_mul_f32 v114, v114, v242
    v_mul_f32 v115, v115, v242
    v_mul_f32 v116, v116, v242
    v_mul_f32 v117, v117, v242
    v_mul_f32 v118, v118, v242
    v_mul_f32 v119, v119, v242
    v_mul_f32 v120, v120, v242
    v_mul_f32 v121, v121, v242
    v_mul_f32 v122, v122, v242
    v_mul_f32 v123, v123, v242
    v_mul_f32 v124, v124, v242
    v_mul_f32 v125, v125, v242
    v_mul_f32 v126, v126, v242
    v_mul_f32 v127, v127, v242
    v_mul_f32 v164, v164, v242
    v_mul_f32 v165, v165, v242
    v_mul_f32 v166, v166, v242
    v_mul_f32 v167, v167, v242
    v_cvt_pk_bf16_f32 v56, v24, v25
    v_cvt_pk_bf16_f32 v57, v26, v27
    v_cvt_pk_bf16_f32 v58, v28, v29
    v_cvt_pk_bf16_f32 v59, v30, v31
    s_nop 1
    v_mfma_f32_16x16x32_bf16 v[96:99], a[32:35], v[56:59], v[96:99]
    v_mfma_f32_16x16x32_bf16 v[100:103], a[36:39], v[56:59], v[100:103]
    v_mfma_f32_16x16x32_bf16 v[104:107], a[40:43], v[56:59], v[104:107]
    v_mfma_f32_16x16x32_bf16 v[108:111], a[44:47], v[56:59], v[108:111]
    v_mfma_f32_16x16x32_bf16 v[112:115], a[48:51], v[56:59], v[112:115]
    v_mfma_f32_16x16x32_bf16 v[116:119], a[52:55], v[56:59], v[116:119]
    v_mfma_f32_16x16x32_bf16 v[120:123], a[56:59], v[56:59], v[120:123]
    v_mfma_f32_16x16x32_bf16 v[124:127], a[60:63], v[56:59], v[124:127]
    v_mfma_f32_16x16x32_bf16 v[164:167], a[64:67], v[56:59], v[164:167]
    v_mfma_f32_16x16x32_bf16 v[32:35], a[0:3], v[204:207], 0
    v_mfma_f32_16x16x32_bf16 v[32:35], a[4:7], v[208:211], v[32:35]
    v_mfma_f32_16x16x32_bf16 v[32:35], a[8:11], v[212:215], v[32:35]
    v_mfma_f32_16x16x32_bf16 v[32:35], a[12:15], v[216:219], v[32:35]
    v_mfma_f32_16x16x32_bf16 v[36:39], a[16:19], v[204:207], 0
    v_mfma_f32_16x16x32_bf16 v[36:39], a[20:23], v[208:211], v[36:39]
    v_mfma_f32_16x16x32_bf16 v[36:39], a[24:27], v[212:215], v[36:39]
    v_mfma_f32_16x16x32_bf16 v[36:39], a[28:31], v[216:219], v[36:39]
    s_nop 3
    v_max3_f32 v241, v32, v33, v34
    s_nop 2
    v_max3_f32 v242, v35, v36, v37
    v_max3_f32 v241, v241, v38, v39
    v_max_f32 v241, v241, v242
    v_mov_b32 v242, v241
    s_nop 1
    v_permlane16_swap_b32 v241, v242
    v_max_f32 v241, v241, v242
    v_mov_b32 v242, v241
    s_nop 1
    v_permlane32_swap_b32 v241, v242
    v_max3_f32 v241, v241, v242, v48
    v_sub_f32 v242, v48, v241
    v_exp_f32 v242, v242
    v_mov_b32 v48, v241
    v_sub_f32 v32, v32, v241
    v_sub_f32 v33, v33, v241
    v_sub_f32 v34, v34, v241
    v_sub_f32 v35, v35, v241
    v_sub_f32 v36, v36, v241
    v_sub_f32 v37, v37, v241
    v_sub_f32 v38, v38, v241
    v_sub_f32 v39, v39, v241
    v_exp_f32 v32, v32
    v_exp_f32 v33, v33
    v_exp_f32 v34, v34
    v_exp_f32 v35, v35
    v_exp_f32 v36, v36
    v_exp_f32 v37, v37
    v_exp_f32 v38, v38
    v_exp_f32 v39, v39
    v_mul_f32 v128, v128, v242
    v_mul_f32 v129, v129, v242
    v_mul_f32 v130, v130, v242
    v_mul_f32 v131, v131, v242
    v_mul_f32 v132, v132, v242
    v_mul_f32 v133, v133, v242
    v_mul_f32 v134, v134, v242
    v_mul_f32 v135, v135, v242
    v_mul_f32 v136, v136, v242
    v_mul_f32 v137, v137, v242
    v_mul_f32 v138, v138, v242
    v_mul_f32 v139, v139, v242
    v_mul_f32 v140, v140, v242
    v_mul_f32 v141, v141, v242
    v_mul_f32 v142, v142, v242
    v_mul_f32 v143, v143, v242
    v_mul_f32 v144, v144, v242
    v_mul_f32 v145, v145, v242
    v_mul_f32 v146, v146, v242
    v_mul_f32 v147, v147, v242
    v_mul_f32 v148, v148, v242
    v_mul_f32 v149, v149, v242
    v_mul_f32 v150, v150, v242
    v_mul_f32 v151, v151, v242
    v_mul_f32 v152, v152, v242
    v_mul_f32 v153, v153, v242
    v_mul_f32 v154, v154, v242
    v_mul_f32 v155, v155, v242
    v_mul_f32 v156, v156, v242
    v_mul_f32 v157, v157, v242
    v_mul_f32 v158, v158, v242
    v_mul_f32 v159, v159, v242
    v_mul_f32 v168, v168, v242
    v_mul_f32 v169, v169, v242
    v_mul_f32 v170, v170, v242
    v_mul_f32 v171, v171, v242
    v_cvt_pk_bf16_f32 v60, v32, v33
    v_cvt_pk_bf16_f32 v61, v34, v35
    v_cvt_pk_bf16_f32 v62, v36, v37
    v_cvt_pk_bf16_f32 v63, v38, v39
    s_nop 1
    v_mfma_f32_16x16x32_bf16 v[128:131], a[32:35], v[60:63], v[128:131]
    v_mfma_f32_16x16x32_bf16 v[132:135], a[36:39], v[60:63], v[132:135]
    v_mfma_f32_16x16x32_bf16 v[136:139], a[40:43], v[60:63], v[136:139]
    v_mfma_f32_16x16x32_bf16 v[140:143], a[44:47], v[60:63], v[140:143]
    v_mfma_f32_16x16x32_bf16 v[144:147], a[48:51], v[60:63], v[144:147]
    v_mfma_f32_16x16x32_bf16 v[148:151], a[52:55], v[60:63], v[148:151]
    v_mfma_f32_16x16x32_bf16 v[152:155], a[56:59], v[60:63], v[152:155]
    v_mfma_f32_16x16x32_bf16 v[156:159], a[60:63], v[60:63], v[156:159]
    v_mfma_f32_16x16x32_bf16 v[168:171], a[64:67], v[60:63], v[168:171]
    s_add_u32 s58, s58, 8192
    s_cmp_lt_u32 s58, 262144
    s_nop 7
    s_cbranch_scc1 L1_slow_loop
    s_nop 7
    v_lshlrev_b32 v245, 4, v0
    v_rcp_f32 v162, v160
    s_nop 0
    v_mov_b32 v163, v162
    v_pk_mul_f32 v[64:65], v[64:65], v[162:163]
    v_pk_mul_f32 v[66:67], v[66:67], v[162:163]
    v_pk_mul_f32 v[68:69], v[68:69], v[162:163]
    v_pk_mul_f32 v[70:71], v[70:71], v[162:163]
    v_cvt_pk_bf16_f32 v64, v64, v65
    v_cvt_pk_bf16_f32 v65, v66, v67
    v_cvt_pk_bf16_f32 v66, v68, v69
    v_cvt_pk_bf16_f32 v67, v70, v71
    buffer_store_dwordx4 v[64:67], v245, s[48:51], s93 offen offset:0 sc1
    v_pk_mul_f32 v[72:73], v[72:73], v[162:163]
    v_pk_mul_f32 v[74:75], v[74:75], v[162:163]
    v_pk_mul_f32 v[76:77], v[76:77], v[162:163]
    v_pk_mul_f32 v[78:79], v[78:79], v[162:163]
    v_cvt_pk_bf16_f32 v72, v72, v73
    v_cvt_pk_bf16_f32 v73, v74, v75
    v_cvt_pk_bf16_f32 v74, v76, v77
    v_cvt_pk_bf16_f32 v75, v78, v79
    buffer_store_dwordx4 v[72:75], v245, s[48:51], s93 offen offset:1024 sc1
    v_pk_mul_f32 v[80:81], v[80:81], v[162:163]
    v_pk_mul_f32 v[82:83], v[82:83], v[162:163]
    v_pk_mul_f32 v[84:85], v[84:85], v[162:163]
    v_pk_mul_f32 v[86:87], v[86:87], v[162:163]
    v_cvt_pk_bf16_f32 v80, v80, v81
    v_cvt_pk_bf16_f32 v81, v82, v83
    v_cvt_pk_bf16_f32 v82, v84, v85
    v_cvt_pk_bf16_f32 v83, v86, v87
    buffer_store_dwordx4 v[80:83], v245, s[48:51], s93 offen offset:2048 sc1
    v_pk_mul_f32 v[88:89], v[88:89], v[162:163]
    v_pk_mul_f32 v[90:91], v[90:91], v[162:163]
    v_pk_mul_f32 v[92:93], v[92:93], v[162:163]
    v_pk_mul_f32 v[94:95], v[94:95], v[162:163]
    v_cvt_pk_bf16_f32 v88, v88, v89
    v_cvt_pk_bf16_f32 v89, v90, v91
    v_cvt_pk_bf16_f32 v90, v92, v93
    v_cvt_pk_bf16_f32 v91, v94, v95
    buffer_store_dwordx4 v[88:91], v245, s[48:51], s93 offen offset:3072 sc1
    v_rcp_f32 v166, v164
    s_nop 0
    v_mov_b32 v167, v166
    v_pk_mul_f32 v[96:97], v[96:97], v[166:167]
    v_pk_mul_f32 v[98:99], v[98:99], v[166:167]
    v_pk_mul_f32 v[100:101], v[100:101], v[166:167]
    v_pk_mul_f32 v[102:103], v[102:103], v[166:167]
    v_cvt_pk_bf16_f32 v96, v96, v97
    v_cvt_pk_bf16_f32 v97, v98, v99
    v_cvt_pk_bf16_f32 v98, v100, v101
    v_cvt_pk_bf16_f32 v99, v102, v103
    buffer_store_dwordx4 v[96:99], v245, s[48:51], s94 offen offset:0 sc1
    v_pk_mul_f32 v[104:105], v[104:105], v[166:167]
    v_pk_mul_f32 v[106:107], v[106:107], v[166:167]
    v_pk_mul_f32 v[108:109], v[108:109], v[166:167]
    v_pk_mul_f32 v[110:111], v[110:111], v[166:167]
    v_cvt_pk_bf16_f32 v104, v104, v105
    v_cvt_pk_bf16_f32 v105, v106, v107
    v_cvt_pk_bf16_f32 v106, v108, v109
    v_cvt_pk_bf16_f32 v107, v110, v111
    buffer_store_dwordx4 v[104:107], v245, s[48:51], s94 offen offset:1024 sc1
    v_pk_mul_f32 v[112:113], v[112:113], v[166:167]
    v_pk_mul_f32 v[114:115], v[114:115], v[166:167]
    v_pk_mul_f32 v[116:117], v[116:117], v[166:167]
    v_pk_mul_f32 v[118:119], v[118:119], v[166:167]
    v_cvt_pk_bf16_f32 v112, v112, v113
    v_cvt_pk_bf16_f32 v113, v114, v115
    v_cvt_pk_bf16_f32 v114, v116, v117
    v_cvt_pk_bf16_f32 v115, v118, v119
    buffer_store_dwordx4 v[112:115], v245, s[48:51], s94 offen offset:2048 sc1
    v_pk_mul_f32 v[120:121], v[120:121], v[166:167]
    v_pk_mul_f32 v[122:123], v[122:123], v[166:167]
    v_pk_mul_f32 v[124:125], v[124:125], v[166:167]
    v_pk_mul_f32 v[126:127], v[126:127], v[166:167]
    v_cvt_pk_bf16_f32 v120, v120, v121
    v_cvt_pk_bf16_f32 v121, v122, v123
    v_cvt_pk_bf16_f32 v122, v124, v125
    v_cvt_pk_bf16_f32 v123, v126, v127
    buffer_store_dwordx4 v[120:123], v245, s[48:51], s94 offen offset:3072 sc1
    v_rcp_f32 v170, v168
    s_nop 0
    v_mov_b32 v171, v170
    v_pk_mul_f32 v[128:129], v[128:129], v[170:171]
    v_pk_mul_f32 v[130:131], v[130:131], v[170:171]
    v_pk_mul_f32 v[132:133], v[132:133], v[170:171]
    v_pk_mul_f32 v[134:135], v[134:135], v[170:171]
    v_cvt_pk_bf16_f32 v128, v128, v129
    v_cvt_pk_bf16_f32 v129, v130, v131
    v_cvt_pk_bf16_f32 v130, v132, v133
    v_cvt_pk_bf16_f32 v131, v134, v135
    buffer_store_dwordx4 v[128:131], v245, s[48:51], s95 offen offset:0 sc1
    v_pk_mul_f32 v[136:137], v[136:137], v[170:171]
    v_pk_mul_f32 v[138:139], v[138:139], v[170:171]
    v_pk_mul_f32 v[140:141], v[140:141], v[170:171]
    v_pk_mul_f32 v[142:143], v[142:143], v[170:171]
    v_cvt_pk_bf16_f32 v136, v136, v137
    v_cvt_pk_bf16_f32 v137, v138, v139
    v_cvt_pk_bf16_f32 v138, v140, v141
    v_cvt_pk_bf16_f32 v139, v142, v143
    buffer_store_dwordx4 v[136:139], v245, s[48:51], s95 offen offset:1024 sc1
    v_pk_mul_f32 v[144:145], v[144:145], v[170:171]
    v_pk_mul_f32 v[146:147], v[146:147], v[170:171]
    v_pk_mul_f32 v[148:149], v[148:149], v[170:171]
    v_pk_mul_f32 v[150:151], v[150:151], v[170:171]
    v_cvt_pk_bf16_f32 v144, v144, v145
    v_cvt_pk_bf16_f32 v145, v146, v147
    v_cvt_pk_bf16_f32 v146, v148, v149
    v_cvt_pk_bf16_f32 v147, v150, v151
    buffer_store_dwordx4 v[144:147], v245, s[48:51], s95 offen offset:2048 sc1
    v_pk_mul_f32 v[152:153], v[152:153], v[170:171]
    v_pk_mul_f32 v[154:155], v[154:155], v[170:171]
    v_pk_mul_f32 v[156:157], v[156:157], v[170:171]
    v_pk_mul_f32 v[158:159], v[158:159], v[170:171]
    v_cvt_pk_bf16_f32 v152, v152, v153
    v_cvt_pk_bf16_f32 v153, v154, v155
    v_cvt_pk_bf16_f32 v154, v156, v157
    v_cvt_pk_bf16_f32 v155, v158, v159
    buffer_store_dwordx4 v[152:155], v245, s[48:51], s95 offen offset:3072 sc1
    s_waitcnt vmcnt(0)
    s_branch L1_fin
.section .rodata,"a"
.p2align 6
.amdhsa_kernel concat_heads__gqa_block_cached__gqa_block_cached__near_ridge_kernel
  .amdhsa_next_free_vgpr 512
  .amdhsa_next_free_sgpr 102
  .amdhsa_accum_offset 256
  .amdhsa_group_segment_fixed_size 0
  .amdhsa_kernarg_size 104
  .amdhsa_user_sgpr_count 2
  .amdhsa_user_sgpr_kernarg_segment_ptr 1
  .amdhsa_system_sgpr_workgroup_id_x 1
.end_amdhsa_kernel
```
